```python
import torch

def _softmax(x, axis=-1):
    return torch.softmax(x, dim=axis)
def _gelu(x):
    return torch.nn.functional.gelu(x, approximate="tanh")
def _silu(x):
    return torch.nn.functional.silu(x)
def _sigmoid(x):
    return torch.sigmoid(x)
def _layernorm(x, axis=-1, eps=1e-5):
    m = x.mean(dim=axis, keepdim=True)
    v = x.var(dim=axis, keepdim=True, unbiased=False)
    return (x - m) / torch.sqrt(v + eps)
def _scatter_add(tgt, idx, src, axis=0):
    return tgt.clone().index_add_(axis, idx, src)
def _segment_sum(src, seg, n):
    out = torch.zeros((n,) + src.shape[1:], dtype=src.dtype)
    return out.index_add_(0, seg, src)
def _pad(x, pw):
    flat = tuple(v for pair in reversed(pw) for v in pair)
    return torch.nn.functional.pad(x, flat)

kernel_name = 'gated_mix__ssm_conv_s4__mha_block__prompt'

def setup_inputs():

    _w = (lambda a: (lambda t: t.to(torch.bfloat16) if t.is_floating_point() else t)(torch.as_tensor(a)))
    def _A_setup():
        B, L, D, N = 1, 2048, 576, 128
        A_re = -(lambda _x: torch.exp(torch.as_tensor(_x)))((lambda *s: torch.randn(*s, dtype=torch.bfloat16) * 6.4)(D, N))
        A_im = torch.pi * (lambda *s: torch.randn(*s, dtype=torch.bfloat16) * 0.1)(D, N)
        B_re = (lambda *s: torch.randn(*s, dtype=torch.bfloat16) * 0.2)(D, N)
        B_im = (lambda *s: torch.randn(*s, dtype=torch.bfloat16) * 0.2)(D, N)
        C_re = (lambda *s: torch.randn(*s, dtype=torch.bfloat16) * 0.2)(D, N)
        C_im = (lambda *s: torch.randn(*s, dtype=torch.bfloat16) * 0.2)(D, N)
        log_dt = (lambda *s: torch.randn(*s, dtype=torch.bfloat16) * 0.1)(D) * 0.5 - 4.0
        Dskip = (lambda *s: torch.randn(*s, dtype=torch.bfloat16) * 0.1)(D)
        return {
            "u": _w((lambda *s: torch.randn(*s, dtype=torch.bfloat16) * 0.05)(B, L, D)),
            "A_re": _w(A_re),
            "A_im": _w(A_im),
            "B_re": _w(B_re),
            "B_im": _w(B_im),
            "C_re": _w(C_re),
            "C_im": _w(C_im),
            "log_dt": _w(log_dt),
            "Dskip": _w(Dskip),
        }
    _A_in = _A_setup()

    def _B_setup():
        B, S, D, H = 1, 2048, 576, 32
        return {
            "x": _w((lambda *s: torch.randn(*s, dtype=torch.bfloat16) * 0.05)(B, S, D)),
            "wqkv": _w((lambda *s: torch.randn(*s, dtype=torch.bfloat16) * 0.8)(D, 3 * D)),
            "wo": _w((lambda *s: torch.randn(*s, dtype=torch.bfloat16) * 0.05)(D, D)),
        }
    _B_in = _B_setup()

    return {
        "A_u": _A_in["u"],
        "A_A_re": _A_in["A_re"],
        "A_A_im": _A_in["A_im"],
        "A_B_re": _A_in["B_re"],
        "A_B_im": _A_in["B_im"],
        "A_C_re": _A_in["C_re"],
        "A_C_im": _A_in["C_im"],
        "A_log_dt": _A_in["log_dt"],
        "A_Dskip": _A_in["Dskip"],
        "B_x": _B_in["x"],
        "B_wqkv": _B_in["wqkv"],
        "B_wo": _B_in["wo"],
        "gate_w": _w((lambda *s: torch.randn(*s, dtype=torch.bfloat16) * 0.05)(576) * 16.0),
    }

def reference(A_u, A_A_re, A_A_im, A_B_re, A_B_im, A_C_re, A_C_im, A_log_dt, A_Dskip, B_x, B_wqkv, B_wo, gate_w):
    def _A_ref(u, A_re, A_im, B_re, B_im, C_re, C_im, log_dt, Dskip):
        Bsz, L, D = u.shape
        dt = torch.exp(log_dt)[:, None]
        A = A_re + 1j * A_im
        Bc = B_re + 1j * B_im
        Cc = C_re + 1j * C_im
        logdA = dt * A
        dB = dt * Bc
        l = (lambda x, dt: x.to(dt))(torch.arange(L), A_re.dtype)
        P = torch.exp(logdA[:, :, None] * l[None, None, :])
        K = torch.einsum("dn,dnl,dn->dl", Cc, P, dB).real
        L2 = 2 * L
        Kp = _pad(K, ((0, 0), (0, L)))
        up = (lambda x, *d: x.permute(*d))(u, 0, 2, 1)
        up = _pad(up, ((0, 0), (0, 0), (0, L)))
        Kf = (lambda x, axes=(-2,-1): torch.fft.rfft2(x.float(), dim=axes))(Kp[:, None, :], axes=(-2, -1))
        Uf = (lambda x, axes=(-2,-1): torch.fft.rfft2(x.float(), dim=axes))(up[:, :, None, :], axes=(-2, -1))
        Yf = Uf * Kf[None, :, :, :]
        y = (lambda x, s, axes=(-2,-1): torch.fft.irfft2(x, s=s, dim=axes).to(torch.bfloat16))(Yf, (1, L2), axes=(-2, -1))[:, :, 0, :L]
        y = (lambda x, *d: x.permute(*d))(y, 0, 2, 1) + u * Dskip[None, None, :]
        return y

    def _B_ref(x, wqkv, wo):
        B, S, D = x.shape
        H = 32
        Dh = D // H
        qkv = (lambda x, *d: x.permute(*d))((x @ wqkv).reshape(B, S, 3, H, Dh), 2, 0, 3, 1, 4)
        q, k, v = qkv[0], qkv[1], qkv[2]
        scores = torch.einsum("bhqd,bhkd->bhqk", q, k) * (Dh ** -0.5)
        p = _softmax(scores, axis=-1)
        o = torch.einsum("bhqk,bhkd->bhqd", p, v)
        return (lambda x, *d: x.permute(*d))(o, 0, 2, 1, 3).reshape(B, S, D) @ wo

    x = A_u
    g = _sigmoid((x * gate_w).sum(-1, keepdims=True))
    a = _A_ref(x, A_A_re, A_A_im, A_B_re, A_B_im, A_C_re, A_C_im, A_log_dt, A_Dskip)
    b = _B_ref(x, B_wqkv, B_wo)
    return g * a + (1 - g) * b
```

```asm
; @launch grid=(256,1,1) block=(768,1,1) lds=163840
.amdgcn_target "amdgcn-amd-amdhsa--gfx950"
.text
.globl gated_mix__ssm_conv_s4__mha_block__prompt_kernel
.p2align 8
.type gated_mix__ssm_conv_s4__mha_block__prompt_kernel,@function
gated_mix__ssm_conv_s4__mha_block__prompt_kernel:
    s_cmp_ge_u32 s2, 256
    s_cbranch_scc1 F_END
    s_load_dwordx2 s[8:9], s[0:1], 0
    s_mov_b32 s74, F_END-F_PC
    s_load_dwordx2 s[12:13], s[0:1], 80
    s_load_dwordx2 s[16:17], s[0:1], 120
    s_load_dwordx16 s[32:47], s[0:1], 8
    s_load_dwordx2 s[4:5], s[0:1], 96
    s_load_dwordx2 s[6:7], s[0:1], 112
    s_getpc_b64 s[70:71]
F_PC:
    s_lshr_b32 s22, s2, 3
    v_lshl_add_u32 v4, v0, 5, s22
    v_lshlrev_b32 v4, 7, v4
    v_mov_b32 v5, s71
    v_cmp_gt_u32 s[72:73], s74, v4
    v_add_co_u32 v4, vcc, s70, v4
    s_and_b32 s21, s2, 7
    s_mov_b32 s10, 2359296
    v_addc_co_u32 v5, vcc, 0, v5, vcc
    s_and_b64 exec, exec, s[72:73]
    s_cbranch_execz F_NP
    global_load_dword v167, v[4:5], off
F_NP:
    s_mov_b64 exec, -1
    v_lshrrev_b32 v2, 6, v0
    v_and_b32 v1, 63, v0
    s_mov_b32 s11, 0x00020000
    v_readfirstlane_b32 s3, v2
    s_mov_b32 s14, 1990656
    s_mov_b32 s15, s11
    s_mov_b32 s18, 15915008
    s_mov_b32 s19, s11
    s_cmp_lt_u32 s22, 28
    s_mov_b32 s23, 1152
    s_cmov_b32 s23, 2112
    s_and_b32 s24, s3, 12
    s_lshr_b32 s23, s23, s24
    s_and_b32 s23, s23, 12
    s_and_b32 s59, s3, 3
    s_or_b32 s20, s59, s23
    s_cmp_eq_u32 s23, 0
    s_cbranch_scc1 F_S
    s_cmp_ge_u32 s22, 28
    s_cbranch_scc1 F_X
    s_cmp_eq_u32 s23, 8
    s_cbranch_scc1 F_C
    s_mul_i32 s28, s22, 37
    s_lshr_b32 s28, s28, 8
    s_mul_i32 s29, s28, 7
    s_sub_u32 s29, s22, s29
    s_lshr_b32 s23, s21, 1
    s_lshl_b32 s23, s23, 2
    s_add_u32 s23, s23, s28
    s_and_b32 s24, s21, 1
    s_mul_i32 s24, s24, 7
    s_add_u32 s24, s24, s29
    s_add_u32 s25, s28, s29
    s_mul_i32 s28, s25, 43
    s_lshr_b32 s28, s28, 7
    s_mul_i32 s28, s28, 3
    s_sub_u32 s25, s25, s28
    s_mul_i32 s25, s25, 3
    s_lshl_b32 s30, s59, 12
    s_add_u32 s30, s30, 32768
    s_lshl_b32 s26, s23, 2
    s_add_u32 s26, s26, s59
    s_mul_i32 s26, s26, 32*1152
    s_mul_i32 s27, s59, 16*3456
    s_lshl_b32 s29, s24, 8
    s_add_u32 s27, s27, s29
    v_lshrrev_b32 v12, 4, v1
    v_and_b32 v11, 7, v1
    v_and_b32 v13, 1, v12
    v_xor_b32 v11, v11, v13
    v_lshlrev_b32 v11, 4, v11
    v_lshrrev_b32 v13, 3, v1
    v_lshrrev_b32 v14, 5, v1
    v_xor_b32 v13, v13, v14
    v_mul_u32_u24 v10, 1152, v13
    v_add_u32 v2, v10, v11
    v_add_u32 v10, 8192, v10
    v_xor_b32 v13, 64, v11
    v_add_u32 v3, v10, v13
    v_add_u32 v10, 8192, v10
    v_xor_b32 v13, 32, v11
    v_add_u32 v4, v10, v13
    v_add_u32 v10, 8192, v10
    v_xor_b32 v13, 96, v11
    v_add_u32 v5, v10, v13
    v_mul_u32_u24 v10, 3456, v12
    v_lshlrev_b32 v12, 2, v12
    v_and_b32 v11, 15, v1
    v_xor_b32 v11, v11, v12
    v_lshl_add_u32 v6, v11, 4, v10
    v_xor_b32 v11, 2, v11
    v_lshl_add_u32 v8, v11, 4, v10
    v_add_u32 v7, 12800, v6
    v_add_u32 v9, 38400, v8
    v_add_u32 v8, 25600, v8
    s_waitcnt lgkmcnt(0)
    s_lshl_b32 s28, s25, 7
    s_add_u32 s28, s28, s26
    s_mul_i32 s29, s25, 221184
    s_add_u32 s29, s29, s27
    s_mov_b32 m0, s30
    s_add_u32 s25, s25, 1
    buffer_load_dwordx4 v2, s[8:11], s28 offen offset:0  lds
    buffer_load_dwordx4 v3, s[8:11], s28 offen offset:1024  lds
    buffer_load_dwordx4 v4, s[8:11], s28 offen offset:2048  lds
    buffer_load_dwordx4 v5, s[8:11], s28 offen offset:3072  lds
    s_add_u32 m0, s30, 16384
    s_cmp_eq_u32 s25, 9
    s_cselect_b32 s25, 0, s25
    buffer_load_dwordx4 v6, s[12:15], s29 offen offset:0  lds
    buffer_load_dwordx4 v7, s[12:15], s29 offen offset:1024  lds
    buffer_load_dwordx4 v8, s[12:15], s29 offen offset:2048  lds
    buffer_load_dwordx4 v9, s[12:15], s29 offen offset:3072  lds
    s_add_u32 s30, s30, 32768
    s_cmp_ge_u32 s30, 98304
    s_cselect_b32 s28, 98304, 0
    s_sub_u32 s30, s30, s28
    s_mov_b32 s40, -1
    s_branch L_IN
.p2align 4
L_LOOP:
    s_waitcnt vmcnt(8)
    s_barrier
L_IN:
    s_lshl_b32 s28, s25, 7
    s_add_u32 s28, s28, s26
    s_mul_i32 s29, s25, 221184
    s_add_u32 s29, s29, s27
    s_mov_b32 m0, s30
    s_add_u32 s25, s25, 1
    buffer_load_dwordx4 v2, s[8:11], s28 offen offset:0  lds
    buffer_load_dwordx4 v3, s[8:11], s28 offen offset:1024  lds
    buffer_load_dwordx4 v4, s[8:11], s28 offen offset:2048  lds
    buffer_load_dwordx4 v5, s[8:11], s28 offen offset:3072  lds
    s_add_u32 m0, s30, 16384
    s_cmp_eq_u32 s25, 9
    s_cselect_b32 s25, 0, s25
    buffer_load_dwordx4 v6, s[12:15], s29 offen offset:0  lds
    buffer_load_dwordx4 v7, s[12:15], s29 offen offset:1024  lds
    buffer_load_dwordx4 v8, s[12:15], s29 offen offset:2048  lds
    buffer_load_dwordx4 v9, s[12:15], s29 offen offset:3072  lds
    s_add_u32 s30, s30, 32768
    s_cmp_ge_u32 s30, 98304
    s_cselect_b32 s28, 98304, 0
    s_sub_u32 s30, s30, s28
    s_add_u32 s40, s40, 1
    s_cmp_lt_u32 s40, 7
    s_cbranch_scc1 L_LOOP
    s_load_dword s60, s[6:7], 0
    s_waitcnt vmcnt(8)
    s_barrier
    s_waitcnt vmcnt(0)
    s_barrier
    s_waitcnt lgkmcnt(0)
    s_cmp_lg_u32 s60, 0
    s_cbranch_scc1 ND_L
    v_mov_b32 v8, 0
    global_load_dword v9, v8, s[6:7] sc1
    s_mov_b32 s65, 20000
NL_L:
    s_waitcnt vmcnt(0)
    v_readfirstlane_b32 s60, v9
    s_nop 0
    s_cmp_lg_u32 s60, 0
    s_cbranch_scc1 ND_L
    s_sleep 2
    global_load_dword v9, v8, s[6:7] sc1
    s_sub_u32 s65, s65, 1
    s_cmp_lg_u32 s65, 0
    s_cbranch_scc1 NL_L
    s_waitcnt vmcnt(0)
ND_L:
    s_branch F_ATT
F_X:
    s_cmp_eq_u32 s23, 8
    s_cbranch_scc1 F_TR
F_S:
    s_memrealtime s[68:69]
    s_sub_u32 s76, s22, 28
    s_max_i32 s76, s76, 0
    s_add_u32 s76, s76, s22
    s_lshl_b32 s76, s76, 2
    s_mul_i32 s77, s21, 144
    s_add_u32 s76, s76, s77
    s_add_u32 s76, s76, s20
    s_lshr_b32 s31, s76, 1
    v_and_b32 v16, 31, v1
    s_lshl_b32 s77, s76, 7
    v_lshl_add_u32 v16, v16, 2, s77
    s_and_b32 s76, s76, -4
    s_waitcnt lgkmcnt(0)
    s_load_dword s48, s[44:45], s76
    s_load_dword s49, s[46:47], s76
    global_load_dword v10, v16, s[32:33]
    global_load_dword v11, v16, s[34:35]
    global_load_dword v12, v16, s[36:37]
    global_load_dword v13, v16, s[38:39]
    global_load_dword v14, v16, s[40:41]
    global_load_dword v15, v16, s[42:43]
    s_and_b32 s25, s20, 1
    s_lshr_b32 s26, s20, 1
    v_mov_b32 v19, 0
    s_lshl_b32 s29, s22, 3
    s_add_u32 s29, s29, s20
    s_cmp_lg_u32 s29, 0
    s_cbranch_scc1 S_NN
    s_or_b32 s68, s68, 1
    v_mov_b32 v18, s68
    s_mov_b64 exec, 1
    global_atomic_cmpswap v19, v[18:19], s[6:7] sc1
    s_mov_b64 exec, -1
S_NN:
F_S2:
    v_lshlrev_b32 v3, 2, v1
    v_add_u32 v3, 163584, v3
    s_cmp_eq_u32 s20, 2
    s_cselect_b32 exec_lo, -1, 0
    s_mov_b32 exec_hi, 0
    ds_write_b32 v3, v19
    s_mov_b64 exec, -1
    s_mul_i32 s51, s26, 17408
    s_cmp_ge_u32 s22, 28
    s_mov_b32 s27, 98304
    s_cmov_b32 s27, 108544
    s_mov_b32 s53, 133120
    s_cmov_b32 s53, 36864
    s_cmp_ge_u32 s26, 2
    s_cmov_b32 s27, 38912
    s_cmov_b32 s53, 46080
    s_add_u32 s51, s51, s27
    s_and_b32 s52, s26, 1
    s_mul_i32 s50, s25, 8704
    s_add_u32 s50, s50, s51
    s_cmp_lt_u32 s22, 28
    s_cbranch_scc1 S_P0
    s_cmp_lg_u32 s20, 2
    s_cbranch_scc1 S_P1
    s_waitcnt lgkmcnt(0)
S_P1:
    s_barrier
    s_cmp_lt_u32 s20, 4
    s_cbranch_scc1 S_P0
    s_setprio 3
S_P0:
    s_cmp_ge_u32 s22, 28
    s_cselect_b64 vcc, -1, 0
    s_bitcmp1_b32 s31, 0
    s_cselect_b32 s28, 0, 16
    s_waitcnt lgkmcnt(0)
    s_lshl_b32 s48, s48, s28
    s_and_b32 s48, s48, 0xffff0000
    s_lshl_b32 s49, s49, s28
    s_and_b32 s49, s49, 0xffff0000
    s_mov_b32 s54, 0x3fb8aa3b
    s_mov_b32 s55, 0x32a57060
    s_mov_b32 s56, 0
    s_mov_b32 s57, -1
    s_mov_b32 s70, 0xffff0000
    s_mov_b32 s71, 0x41800000
    s_mov_b32 s72, 0x43800000
    v_mov_b32 v22, s48
    v_mul_f32 v23, s54, v22
    v_fma_f32 v24, s54, v22, -v23
    v_fma_f32 v24, s55, v22, v24
    v_exp_f32 v23, v23
    v_mul_f32 v24, 0x3f317218, v24
    v_fma_f32 v23, v23, v24, v23
    v_cvt_pk_bf16_f32 v23, v23, v23
    v_and_b32 v7, 0xffff0000, v23
    s_and_b32 s30, s20, 3
    s_cmp_ge_u32 s22, 28
    s_cselect_b32 s30, 0, s30
    s_waitcnt vmcnt(1)
    s_cmp_eq_u32 s29, 0
    s_cbranch_scc1 S_W1
    s_waitcnt vmcnt(0)
S_W1:
.p2align 3
    v_lshlrev_b32 v44, 16, v10
    v_and_b32 v100, s70, v10
    v_lshlrev_b32 v45, 16, v11
    v_and_b32 v101, s70, v11
    v_lshlrev_b32 v46, 16, v12
    v_and_b32 v102, s70, v12
    v_lshlrev_b32 v47, 16, v13
    v_and_b32 v103, s70, v13
    v_lshlrev_b32 v48, 16, v14
    v_and_b32 v104, s70, v14
    v_lshlrev_b32 v49, 16, v15
    v_and_b32 v105, s70, v15
    v_mul_f32 v44, v7, v44
    v_mul_f32 v100, v7, v100
    v_mul_f32 v45, v7, v45
    v_mul_f32 v101, v7, v101
    v_mul_f32 v46, v7, v46
    v_mul_f32 v102, v7, v102
    v_mul_f32 v47, v7, v47
    v_mul_f32 v103, v7, v103
    v_mul_f32 v44, s54, v44
    v_mul_f32 v100, s54, v100
    v_mul_f32 v45, 0.15915494, v45
    v_mul_f32 v101, 0.15915494, v101
    v_pk_mul_f32 v[50:51], v[48:49], v[46:47] op_sel:[0,0] op_sel_hi:[0,1]
    v_pk_mul_f32 v[106:107], v[104:105], v[102:103] op_sel:[0,0] op_sel_hi:[0,1]
    v_pk_fma_f32 v[50:51], v[48:49], v[46:47], v[50:51] op_sel:[1,1,0] op_sel_hi:[1,0,1] neg_lo:[1,0,0]
    v_pk_fma_f32 v[106:107], v[104:105], v[102:103], v[106:107] op_sel:[1,1,0] op_sel_hi:[1,0,1] neg_lo:[1,0,0]
    v_fract_f32 v53, v45
    v_fract_f32 v109, v101
    v_exp_f32 v52, v44
    v_exp_f32 v108, v100
    v_cos_f32 v54, v53
    v_cos_f32 v110, v109
    v_sin_f32 v55, v53
    v_sin_f32 v111, v109
    v_mul_f32 v56, s71, v44
    v_mul_f32 v112, s71, v100
    v_mul_f32 v57, s71, v45
    v_mul_f32 v113, s71, v101
    v_fract_f32 v57, v57
    v_fract_f32 v113, v113
    v_exp_f32 v56, v56
    v_exp_f32 v112, v112
    v_cos_f32 v58, v57
    v_cos_f32 v114, v113
    v_sin_f32 v59, v57
    v_sin_f32 v115, v113
    v_mul_f32 v60, s72, v44
    v_mul_f32 v116, s72, v100
    v_mul_f32 v61, s72, v45
    v_mul_f32 v117, s72, v101
    v_fract_f32 v61, v61
    v_fract_f32 v117, v117
    v_exp_f32 v60, v60
    v_exp_f32 v116, v116
    v_cos_f32 v62, v61
    v_cos_f32 v118, v117
    v_sin_f32 v63, v61
    v_sin_f32 v119, v117
    v_pk_mul_f32 v[18:19], v[52:53], v[54:55] op_sel:[0,0] op_sel_hi:[0,1]
    v_pk_mul_f32 v[32:33], v[108:109], v[110:111] op_sel:[0,0] op_sel_hi:[0,1]
    v_pk_mul_f32 v[24:25], v[56:57], v[58:59] op_sel:[0,0] op_sel_hi:[0,1]
    v_pk_mul_f32 v[38:39], v[112:113], v[114:115] op_sel:[0,0] op_sel_hi:[0,1]
    v_pk_mul_f32 v[22:23], v[60:61], v[62:63] op_sel:[0,0] op_sel_hi:[0,1]
    v_pk_mul_f32 v[36:37], v[116:117], v[118:119] op_sel:[0,0] op_sel_hi:[0,1]
    v_pk_mul_f32 v[20:21], v[18:19], v[18:19] op_sel:[0,0] op_sel_hi:[0,1]
    v_pk_mul_f32 v[34:35], v[32:33], v[32:33] op_sel:[0,0] op_sel_hi:[0,1]
    v_pk_fma_f32 v[20:21], v[18:19], v[18:19], v[20:21] op_sel:[1,1,0] op_sel_hi:[1,0,1] neg_lo:[1,0,0]
    v_pk_fma_f32 v[34:35], v[32:33], v[32:33], v[34:35] op_sel:[1,1,0] op_sel_hi:[1,0,1] neg_lo:[1,0,0]
    v_pk_mul_f32 v[46:47], v[20:21], v[20:21] op_sel:[0,0] op_sel_hi:[0,1]
    v_pk_mul_f32 v[102:103], v[34:35], v[34:35] op_sel:[0,0] op_sel_hi:[0,1]
    v_pk_fma_f32 v[46:47], v[20:21], v[20:21], v[46:47] op_sel:[1,1,0] op_sel_hi:[1,0,1] neg_lo:[1,0,0]
    v_pk_fma_f32 v[102:103], v[34:35], v[34:35], v[102:103] op_sel:[1,1,0] op_sel_hi:[1,0,1] neg_lo:[1,0,0]
    v_cndmask_b32 v46, 1.0, v46, s[56:57]
    v_cndmask_b32 v102, 1.0, v102, s[56:57]
    v_cndmask_b32 v47, 0, v47, s[56:57]
    v_cndmask_b32 v103, 0, v103, s[56:57]
    v_pk_mul_f32 v[26:27], v[46:47], v[46:47] op_sel:[0,0] op_sel_hi:[0,1]
    v_pk_mul_f32 v[40:41], v[102:103], v[102:103] op_sel:[0,0] op_sel_hi:[0,1]
    v_pk_mul_f32 v[16:17], v[50:51], v[46:47] op_sel:[0,0] op_sel_hi:[0,1]
    v_pk_mul_f32 v[30:31], v[106:107], v[102:103] op_sel:[0,0] op_sel_hi:[0,1]
    v_pk_fma_f32 v[26:27], v[46:47], v[46:47], v[26:27] op_sel:[1,1,0] op_sel_hi:[1,0,1] neg_lo:[1,0,0]
    v_pk_fma_f32 v[40:41], v[102:103], v[102:103], v[40:41] op_sel:[1,1,0] op_sel_hi:[1,0,1] neg_lo:[1,0,0]
    v_pk_fma_f32 v[16:17], v[50:51], v[46:47], v[16:17] op_sel:[1,1,0] op_sel_hi:[1,0,1] neg_lo:[1,0,0]
    v_pk_fma_f32 v[30:31], v[106:107], v[102:103], v[30:31] op_sel:[1,1,0] op_sel_hi:[1,0,1] neg_lo:[1,0,0]
    v_cvt_pk_bf16_f32 v68, v26, v27
    v_cvt_pk_bf16_f32 v69, v40, v41
    v_pk_mul_f32 v[28:29], v[26:27], v[24:25] op_sel:[0,0] op_sel_hi:[0,1]
    v_pk_mul_f32 v[42:43], v[40:41], v[38:39] op_sel:[0,0] op_sel_hi:[0,1]
    v_pk_fma_f32 v[28:29], v[26:27], v[24:25], v[28:29] op_sel:[1,1,0] op_sel_hi:[1,0,1] neg_lo:[1,0,0]
    v_pk_fma_f32 v[42:43], v[40:41], v[38:39], v[42:43] op_sel:[1,1,0] op_sel_hi:[1,0,1] neg_lo:[1,0,0]
    v_cvt_pk_bf16_f32 v70, v28, v29
    v_cvt_pk_bf16_f32 v71, v42, v43
    v_pk_mul_f32 v[26:27], v[28:29], v[24:25] op_sel:[0,0] op_sel_hi:[0,1]
    v_pk_mul_f32 v[40:41], v[42:43], v[38:39] op_sel:[0,0] op_sel_hi:[0,1]
    v_pk_fma_f32 v[26:27], v[28:29], v[24:25], v[26:27] op_sel:[1,1,0] op_sel_hi:[1,0,1] neg_lo:[1,0,0]
    v_pk_fma_f32 v[40:41], v[42:43], v[38:39], v[40:41] op_sel:[1,1,0] op_sel_hi:[1,0,1] neg_lo:[1,0,0]
    v_cvt_pk_bf16_f32 v72, v26, v27
    v_cvt_pk_bf16_f32 v73, v40, v41
    v_pk_mul_f32 v[28:29], v[26:27], v[24:25] op_sel:[0,0] op_sel_hi:[0,1]
    v_pk_mul_f32 v[42:43], v[40:41], v[38:39] op_sel:[0,0] op_sel_hi:[0,1]
    v_pk_fma_f32 v[28:29], v[26:27], v[24:25], v[28:29] op_sel:[1,1,0] op_sel_hi:[1,0,1] neg_lo:[1,0,0]
    v_pk_fma_f32 v[42:43], v[40:41], v[38:39], v[42:43] op_sel:[1,1,0] op_sel_hi:[1,0,1] neg_lo:[1,0,0]
    v_cvt_pk_bf16_f32 v74, v28, v29
    v_cvt_pk_bf16_f32 v75, v42, v43
    v_pk_mul_f32 v[26:27], v[28:29], v[24:25] op_sel:[0,0] op_sel_hi:[0,1]
    v_pk_mul_f32 v[40:41], v[42:43], v[38:39] op_sel:[0,0] op_sel_hi:[0,1]
    v_pk_fma_f32 v[26:27], v[28:29], v[24:25], v[26:27] op_sel:[1,1,0] op_sel_hi:[1,0,1] neg_lo:[1,0,0]
    v_pk_fma_f32 v[40:41], v[42:43], v[38:39], v[40:41] op_sel:[1,1,0] op_sel_hi:[1,0,1] neg_lo:[1,0,0]
    v_cvt_pk_bf16_f32 v76, v26, v27
    v_cvt_pk_bf16_f32 v77, v40, v41
    v_pk_mul_f32 v[28:29], v[26:27], v[24:25] op_sel:[0,0] op_sel_hi:[0,1]
    v_pk_mul_f32 v[42:43], v[40:41], v[38:39] op_sel:[0,0] op_sel_hi:[0,1]
    v_pk_fma_f32 v[28:29], v[26:27], v[24:25], v[28:29] op_sel:[1,1,0] op_sel_hi:[1,0,1] neg_lo:[1,0,0]
    v_pk_fma_f32 v[42:43], v[40:41], v[38:39], v[42:43] op_sel:[1,1,0] op_sel_hi:[1,0,1] neg_lo:[1,0,0]
    v_cvt_pk_bf16_f32 v78, v28, v29
    v_cvt_pk_bf16_f32 v79, v42, v43
    v_pk_mul_f32 v[26:27], v[28:29], v[24:25] op_sel:[0,0] op_sel_hi:[0,1]
    v_pk_mul_f32 v[40:41], v[42:43], v[38:39] op_sel:[0,0] op_sel_hi:[0,1]
    v_pk_fma_f32 v[26:27], v[28:29], v[24:25], v[26:27] op_sel:[1,1,0] op_sel_hi:[1,0,1] neg_lo:[1,0,0]
    v_pk_fma_f32 v[40:41], v[42:43], v[38:39], v[40:41] op_sel:[1,1,0] op_sel_hi:[1,0,1] neg_lo:[1,0,0]
    v_cvt_pk_bf16_f32 v80, v26, v27
    v_cvt_pk_bf16_f32 v81, v40, v41
    v_pk_mul_f32 v[28:29], v[26:27], v[24:25] op_sel:[0,0] op_sel_hi:[0,1]
    v_pk_mul_f32 v[42:43], v[40:41], v[38:39] op_sel:[0,0] op_sel_hi:[0,1]
    v_pk_fma_f32 v[28:29], v[26:27], v[24:25], v[28:29] op_sel:[1,1,0] op_sel_hi:[1,0,1] neg_lo:[1,0,0]
    v_pk_fma_f32 v[42:43], v[40:41], v[38:39], v[42:43] op_sel:[1,1,0] op_sel_hi:[1,0,1] neg_lo:[1,0,0]
    v_cvt_pk_bf16_f32 v82, v28, v29
    v_cvt_pk_bf16_f32 v83, v42, v43
    v_pk_mul_f32 v[26:27], v[28:29], v[24:25] op_sel:[0,0] op_sel_hi:[0,1]
    v_pk_mul_f32 v[40:41], v[42:43], v[38:39] op_sel:[0,0] op_sel_hi:[0,1]
    v_pk_fma_f32 v[26:27], v[28:29], v[24:25], v[26:27] op_sel:[1,1,0] op_sel_hi:[1,0,1] neg_lo:[1,0,0]
    v_pk_fma_f32 v[40:41], v[42:43], v[38:39], v[40:41] op_sel:[1,1,0] op_sel_hi:[1,0,1] neg_lo:[1,0,0]
    v_cvt_pk_bf16_f32 v84, v26, v27
    v_cvt_pk_bf16_f32 v85, v40, v41
    v_pk_mul_f32 v[28:29], v[26:27], v[24:25] op_sel:[0,0] op_sel_hi:[0,1]
    v_pk_mul_f32 v[42:43], v[40:41], v[38:39] op_sel:[0,0] op_sel_hi:[0,1]
    v_pk_fma_f32 v[28:29], v[26:27], v[24:25], v[28:29] op_sel:[1,1,0] op_sel_hi:[1,0,1] neg_lo:[1,0,0]
    v_pk_fma_f32 v[42:43], v[40:41], v[38:39], v[42:43] op_sel:[1,1,0] op_sel_hi:[1,0,1] neg_lo:[1,0,0]
    v_cvt_pk_bf16_f32 v86, v28, v29
    v_cvt_pk_bf16_f32 v87, v42, v43
    v_pk_mul_f32 v[26:27], v[28:29], v[24:25] op_sel:[0,0] op_sel_hi:[0,1]
    v_pk_mul_f32 v[40:41], v[42:43], v[38:39] op_sel:[0,0] op_sel_hi:[0,1]
    v_pk_fma_f32 v[26:27], v[28:29], v[24:25], v[26:27] op_sel:[1,1,0] op_sel_hi:[1,0,1] neg_lo:[1,0,0]
    v_pk_fma_f32 v[40:41], v[42:43], v[38:39], v[40:41] op_sel:[1,1,0] op_sel_hi:[1,0,1] neg_lo:[1,0,0]
    v_cvt_pk_bf16_f32 v88, v26, v27
    v_cvt_pk_bf16_f32 v89, v40, v41
    v_pk_mul_f32 v[28:29], v[26:27], v[24:25] op_sel:[0,0] op_sel_hi:[0,1]
    v_pk_mul_f32 v[42:43], v[40:41], v[38:39] op_sel:[0,0] op_sel_hi:[0,1]
    v_pk_fma_f32 v[28:29], v[26:27], v[24:25], v[28:29] op_sel:[1,1,0] op_sel_hi:[1,0,1] neg_lo:[1,0,0]
    v_pk_fma_f32 v[42:43], v[40:41], v[38:39], v[42:43] op_sel:[1,1,0] op_sel_hi:[1,0,1] neg_lo:[1,0,0]
    v_cvt_pk_bf16_f32 v90, v28, v29
    v_cvt_pk_bf16_f32 v91, v42, v43
    v_pk_mul_f32 v[26:27], v[28:29], v[24:25] op_sel:[0,0] op_sel_hi:[0,1]
    v_pk_mul_f32 v[40:41], v[42:43], v[38:39] op_sel:[0,0] op_sel_hi:[0,1]
    v_pk_fma_f32 v[26:27], v[28:29], v[24:25], v[26:27] op_sel:[1,1,0] op_sel_hi:[1,0,1] neg_lo:[1,0,0]
    v_pk_fma_f32 v[40:41], v[42:43], v[38:39], v[40:41] op_sel:[1,1,0] op_sel_hi:[1,0,1] neg_lo:[1,0,0]
    v_cvt_pk_bf16_f32 v92, v26, v27
    v_cvt_pk_bf16_f32 v93, v40, v41
    v_pk_mul_f32 v[28:29], v[26:27], v[24:25] op_sel:[0,0] op_sel_hi:[0,1]
    v_pk_mul_f32 v[42:43], v[40:41], v[38:39] op_sel:[0,0] op_sel_hi:[0,1]
    v_pk_fma_f32 v[28:29], v[26:27], v[24:25], v[28:29] op_sel:[1,1,0] op_sel_hi:[1,0,1] neg_lo:[1,0,0]
    v_pk_fma_f32 v[42:43], v[40:41], v[38:39], v[42:43] op_sel:[1,1,0] op_sel_hi:[1,0,1] neg_lo:[1,0,0]
    v_cvt_pk_bf16_f32 v94, v28, v29
    v_cvt_pk_bf16_f32 v95, v42, v43
    v_pk_mul_f32 v[26:27], v[28:29], v[24:25] op_sel:[0,0] op_sel_hi:[0,1]
    v_pk_mul_f32 v[40:41], v[42:43], v[38:39] op_sel:[0,0] op_sel_hi:[0,1]
    v_pk_fma_f32 v[26:27], v[28:29], v[24:25], v[26:27] op_sel:[1,1,0] op_sel_hi:[1,0,1] neg_lo:[1,0,0]
    v_pk_fma_f32 v[40:41], v[42:43], v[38:39], v[40:41] op_sel:[1,1,0] op_sel_hi:[1,0,1] neg_lo:[1,0,0]
    v_cvt_pk_bf16_f32 v96, v26, v27
    v_cvt_pk_bf16_f32 v97, v40, v41
    v_pk_mul_f32 v[28:29], v[26:27], v[24:25] op_sel:[0,0] op_sel_hi:[0,1]
    v_pk_mul_f32 v[42:43], v[40:41], v[38:39] op_sel:[0,0] op_sel_hi:[0,1]
    v_pk_fma_f32 v[28:29], v[26:27], v[24:25], v[28:29] op_sel:[1,1,0] op_sel_hi:[1,0,1] neg_lo:[1,0,0]
    v_pk_fma_f32 v[42:43], v[40:41], v[38:39], v[42:43] op_sel:[1,1,0] op_sel_hi:[1,0,1] neg_lo:[1,0,0]
    v_cvt_pk_bf16_f32 v98, v28, v29
    v_cvt_pk_bf16_f32 v99, v42, v43
    v_cvt_pk_bf16_f32 v100, v16, -v17
    v_cvt_pk_bf16_f32 v101, v30, -v31
    v_pk_mul_f32 v[44:45], v[16:17], v[18:19] op_sel:[0,0] op_sel_hi:[0,1]
    v_pk_mul_f32 v[46:47], v[30:31], v[32:33] op_sel:[0,0] op_sel_hi:[0,1]
    v_pk_fma_f32 v[44:45], v[16:17], v[18:19], v[44:45] op_sel:[1,1,0] op_sel_hi:[1,0,1] neg_lo:[1,0,0]
    v_pk_fma_f32 v[46:47], v[30:31], v[32:33], v[46:47] op_sel:[1,1,0] op_sel_hi:[1,0,1] neg_lo:[1,0,0]
    v_cvt_pk_bf16_f32 v102, v44, -v45
    v_cvt_pk_bf16_f32 v103, v46, -v47
    v_pk_mul_f32 v[48:49], v[16:17], v[20:21] op_sel:[0,0] op_sel_hi:[0,1]
    v_pk_mul_f32 v[50:51], v[30:31], v[34:35] op_sel:[0,0] op_sel_hi:[0,1]
    v_pk_fma_f32 v[48:49], v[16:17], v[20:21], v[48:49] op_sel:[1,1,0] op_sel_hi:[1,0,1] neg_lo:[1,0,0]
    v_pk_fma_f32 v[50:51], v[30:31], v[34:35], v[50:51] op_sel:[1,1,0] op_sel_hi:[1,0,1] neg_lo:[1,0,0]
    v_cvt_pk_bf16_f32 v104, v48, -v49
    v_cvt_pk_bf16_f32 v105, v50, -v51
    v_pk_mul_f32 v[48:49], v[44:45], v[20:21] op_sel:[0,0] op_sel_hi:[0,1]
    v_pk_mul_f32 v[50:51], v[46:47], v[34:35] op_sel:[0,0] op_sel_hi:[0,1]
    v_pk_fma_f32 v[48:49], v[44:45], v[20:21], v[48:49] op_sel:[1,1,0] op_sel_hi:[1,0,1] neg_lo:[1,0,0]
    v_pk_fma_f32 v[50:51], v[46:47], v[34:35], v[50:51] op_sel:[1,1,0] op_sel_hi:[1,0,1] neg_lo:[1,0,0]
    v_cvt_pk_bf16_f32 v106, v48, -v49
    v_cvt_pk_bf16_f32 v107, v50, -v51
    v_pk_mul_f32 v[26:27], v[16:17], v[22:23] op_sel:[0,0] op_sel_hi:[0,1]
    v_pk_mul_f32 v[40:41], v[30:31], v[36:37] op_sel:[0,0] op_sel_hi:[0,1]
    v_pk_fma_f32 v[26:27], v[16:17], v[22:23], v[26:27] op_sel:[1,1,0] op_sel_hi:[1,0,1] neg_lo:[1,0,0]
    v_pk_fma_f32 v[40:41], v[30:31], v[36:37], v[40:41] op_sel:[1,1,0] op_sel_hi:[1,0,1] neg_lo:[1,0,0]
    v_cvt_pk_bf16_f32 v108, v26, -v27
    v_cvt_pk_bf16_f32 v109, v40, -v41
    v_pk_mul_f32 v[44:45], v[26:27], v[20:21] op_sel:[0,0] op_sel_hi:[0,1]
    v_pk_mul_f32 v[46:47], v[40:41], v[34:35] op_sel:[0,0] op_sel_hi:[0,1]
    v_pk_fma_f32 v[44:45], v[26:27], v[20:21], v[44:45] op_sel:[1,1,0] op_sel_hi:[1,0,1] neg_lo:[1,0,0]
    v_pk_fma_f32 v[46:47], v[40:41], v[34:35], v[46:47] op_sel:[1,1,0] op_sel_hi:[1,0,1] neg_lo:[1,0,0]
    v_cvt_pk_bf16_f32 v110, v44, -v45
    v_cvt_pk_bf16_f32 v111, v46, -v47
    v_pk_mul_f32 v[28:29], v[26:27], v[22:23] op_sel:[0,0] op_sel_hi:[0,1]
    v_pk_mul_f32 v[42:43], v[40:41], v[36:37] op_sel:[0,0] op_sel_hi:[0,1]
    v_pk_fma_f32 v[28:29], v[26:27], v[22:23], v[28:29] op_sel:[1,1,0] op_sel_hi:[1,0,1] neg_lo:[1,0,0]
    v_pk_fma_f32 v[42:43], v[40:41], v[36:37], v[42:43] op_sel:[1,1,0] op_sel_hi:[1,0,1] neg_lo:[1,0,0]
    v_cvt_pk_bf16_f32 v112, v28, -v29
    v_cvt_pk_bf16_f32 v113, v42, -v43
    v_pk_mul_f32 v[26:27], v[28:29], v[22:23] op_sel:[0,0] op_sel_hi:[0,1]
    v_pk_mul_f32 v[40:41], v[42:43], v[36:37] op_sel:[0,0] op_sel_hi:[0,1]
    v_pk_fma_f32 v[26:27], v[28:29], v[22:23], v[26:27] op_sel:[1,1,0] op_sel_hi:[1,0,1] neg_lo:[1,0,0]
    v_pk_fma_f32 v[40:41], v[42:43], v[36:37], v[40:41] op_sel:[1,1,0] op_sel_hi:[1,0,1] neg_lo:[1,0,0]
    v_cvt_pk_bf16_f32 v114, v26, -v27
    v_cvt_pk_bf16_f32 v115, v40, -v41
    v_pk_mul_f32 v[28:29], v[26:27], v[22:23] op_sel:[0,0] op_sel_hi:[0,1]
    v_pk_mul_f32 v[42:43], v[40:41], v[36:37] op_sel:[0,0] op_sel_hi:[0,1]
    v_pk_fma_f32 v[28:29], v[26:27], v[22:23], v[28:29] op_sel:[1,1,0] op_sel_hi:[1,0,1] neg_lo:[1,0,0]
    v_pk_fma_f32 v[42:43], v[40:41], v[36:37], v[42:43] op_sel:[1,1,0] op_sel_hi:[1,0,1] neg_lo:[1,0,0]
    v_cvt_pk_bf16_f32 v116, v28, -v29
    v_cvt_pk_bf16_f32 v117, v42, -v43
    v_pk_mul_f32 v[26:27], v[28:29], v[22:23] op_sel:[0,0] op_sel_hi:[0,1]
    v_pk_mul_f32 v[40:41], v[42:43], v[36:37] op_sel:[0,0] op_sel_hi:[0,1]
    v_pk_fma_f32 v[26:27], v[28:29], v[22:23], v[26:27] op_sel:[1,1,0] op_sel_hi:[1,0,1] neg_lo:[1,0,0]
    v_pk_fma_f32 v[40:41], v[42:43], v[36:37], v[40:41] op_sel:[1,1,0] op_sel_hi:[1,0,1] neg_lo:[1,0,0]
    v_cvt_pk_bf16_f32 v118, v26, -v27
    v_cvt_pk_bf16_f32 v119, v40, -v41
    v_pk_mul_f32 v[28:29], v[26:27], v[22:23] op_sel:[0,0] op_sel_hi:[0,1]
    v_pk_mul_f32 v[42:43], v[40:41], v[36:37] op_sel:[0,0] op_sel_hi:[0,1]
    v_pk_fma_f32 v[28:29], v[26:27], v[22:23], v[28:29] op_sel:[1,1,0] op_sel_hi:[1,0,1] neg_lo:[1,0,0]
    v_pk_fma_f32 v[42:43], v[40:41], v[36:37], v[42:43] op_sel:[1,1,0] op_sel_hi:[1,0,1] neg_lo:[1,0,0]
    v_cvt_pk_bf16_f32 v120, v28, -v29
    v_cvt_pk_bf16_f32 v121, v42, -v43
    v_pk_mul_f32 v[26:27], v[28:29], v[22:23] op_sel:[0,0] op_sel_hi:[0,1]
    v_pk_mul_f32 v[40:41], v[42:43], v[36:37] op_sel:[0,0] op_sel_hi:[0,1]
    v_pk_fma_f32 v[26:27], v[28:29], v[22:23], v[26:27] op_sel:[1,1,0] op_sel_hi:[1,0,1] neg_lo:[1,0,0]
    v_pk_fma_f32 v[40:41], v[42:43], v[36:37], v[40:41] op_sel:[1,1,0] op_sel_hi:[1,0,1] neg_lo:[1,0,0]
    v_cvt_pk_bf16_f32 v122, v26, -v27
    v_cvt_pk_bf16_f32 v123, v40, -v41
    v_pk_mul_f32 v[28:29], v[26:27], v[22:23] op_sel:[0,0] op_sel_hi:[0,1]
    v_pk_mul_f32 v[42:43], v[40:41], v[36:37] op_sel:[0,0] op_sel_hi:[0,1]
    v_pk_fma_f32 v[28:29], v[26:27], v[22:23], v[28:29] op_sel:[1,1,0] op_sel_hi:[1,0,1] neg_lo:[1,0,0]
    v_pk_fma_f32 v[42:43], v[40:41], v[36:37], v[42:43] op_sel:[1,1,0] op_sel_hi:[1,0,1] neg_lo:[1,0,0]
    v_cvt_pk_bf16_f32 v124, v28, -v29
    v_cvt_pk_bf16_f32 v125, v42, -v43
    s_cbranch_vccnz S_B1
    s_barrier
S_B1:
S_C1:
    v_and_b32 v16, 31, v1
    v_lshrrev_b32 v17, 5, v1
    v_lshlrev_b32 v18, 3, v16
    v_add_u32 v18, s50, v18
    v_mul_u32_u24 v19, 272, v17
    v_add_u32 v164, v18, v19
    v_lshl_add_u32 v165, v19, 1, v18
    v_lshl_add_u32 v166, v19, 2, v18
    v_mul_u32_u24 v18, 272, v16
    v_lshl_add_u32 v18, v17, 4, v18
    v_mov_b32 v66, v18
    v_lshlrev_b32 v18, 5, v16
    v_lshl_add_u32 v18, v17, 4, v18
    v_add_u32 v149, s50, v18
    v_sub_u32 v19, 4, v17
    v_lshlrev_b32 v19, v19, v16
    v_lshl_add_u32 v19, v17, 9, v19
    v_add_u32 v150, s50, v19
    v_mul_u32_u24 v20, 248, v17
    v_add_u32 v151, v150, v20
    v_lshlrev_b32 v20, 2, v16
    v_lshl_add_u32 v20, v17, 8, v20
    v_add_u32 v152, s50, v20
    v_lshlrev_b32 v18, 4, v1
    v_add_u32 v153, s51, v18
    v_add_u32 v160, s50, v18
    v_lshlrev_b32 v19, 3, v1
    v_add_u32 v154, s51, v19
    v_add_u32 v154, 1024, v154
    v_add_u32 v136, 8704, v154
    s_lshl_b32 s68, s25, 6
    s_add_u32 s68, s68, s50
    s_add_u32 s69, s68, 6112
    v_lshlrev_b32 v20, 5, v1
    s_cbranch_vccnz S_B2
    s_barrier
S_B2:
S_C2:
    s_load_dword s60, s[6:7], 0
    v_sub_u32 v155, s69, v20
    s_add_u32 s69, s68, 7152
    v_sub_u32 v156, s69, v18
    s_add_u32 s69, s68, 7672
    v_sub_u32 v157, s69, v19
    v_lshlrev_b32 v20, 2, v1
    v_add_u32 v158, s68, v20
    v_add_u32 v161, s53, v18
    v_mov_b32 v159, 0
    v_writelane_b32 v159, s49, 0
    v_subrev_u32 v146, 4, v153
    v_and_b32 v18, 1, v1
    v_mul_u32_u24 v18, 8768, v18
    v_and_b32 v19, 14, v1
    v_lshl_add_u32 v18, v19, 1, v18
    v_bfe_u32 v20, v1, 4, 1
    v_lshlrev_b32 v19, 5, v20
    v_lshl_add_u32 v19, v17, 4, v19
    s_lshl_b32 s68, s25, 8
    s_sub_u32 s68, s51, s68
    s_add_u32 s68, s68, 16220
    v_sub_u32 v140, s68, v18
    v_add_u32 v140, v140, v19
    v_subrev_u32 v141, 1024, v140
    v_subrev_u32 v142, 2048, v140
    v_subrev_u32 v143, 3072, v140
    v_lshl_add_u32 v19, v17, 1, s52
    s_lshl_b32 s68, s25, 3
    s_sub_u32 s68, 15, s68
    v_and_b32 v21, 15, v1
    v_add3_u32 v16, v21, v20, s68
    s_cbranch_vccnz S_B3
    s_barrier
S_B3:
S_C3:
    v_bfe_u32 v18, v16, 2, 2
    v_xor_b32 v18, v18, v19
    v_lshlrev_b32 v18, 4, v18
    v_lshl_add_u32 v18, v16, 6, v18
    v_add_u32 v132, s53, v18
    v_subrev_u32 v16, 2, v16
    v_bfe_u32 v18, v16, 2, 2
    v_xor_b32 v18, v18, v19
    v_lshlrev_b32 v18, 4, v18
    v_lshl_add_u32 v18, v16, 6, v18
    v_add_u32 v133, s53, v18
    v_subrev_u32 v16, 2, v16
    v_bfe_u32 v18, v16, 2, 2
    v_xor_b32 v18, v18, v19
    v_lshlrev_b32 v18, 4, v18
    v_lshl_add_u32 v18, v16, 6, v18
    v_add_u32 v134, s53, v18
    v_subrev_u32 v16, 2, v16
    v_bfe_u32 v18, v16, 2, 2
    v_xor_b32 v18, v18, v19
    v_lshlrev_b32 v18, 4, v18
    v_lshl_add_u32 v18, v16, 6, v18
    v_add_u32 v135, s53, v18
    v_subrev_u32 v16, 2, v16
    v_lshrrev_b32 v18, 4, v1
    v_lshlrev_b32 v18, 3, v18
    v_lshl_add_u32 v145, v21, 5, v18
    s_lshl_b32 s68, s20, 2
    s_add_u32 s68, s68, 163664
    v_mov_b32 v147, s68
    v_xor_b32 v148, 4, v147
    s_and_b32 s68, s68, -16
    v_and_b32 v18, 3, v1
    s_cbranch_vccnz S_B4
    s_barrier
S_B4:
S_C4:
    v_lshl_add_u32 v144, v18, 2, s68
    v_mov_b32 v9, v144
    s_lshr_b32 s69, s20, 2
    s_lshl_b32 s69, s69, 2
    s_add_u32 s69, s69, 163696
    s_cmp_ge_u32 s22, 28
    s_cselect_b32 s68, s69, s68
    v_writelane_b32 v9, s68, 63
    v_sub_u32 v4, v166, v165
    v_lshl_add_u32 v4, v4, 1, v166
    v_add_u32 v167, s50, v66
    s_lshr_b32 s26, s31, 2
    s_mul_i32 s26, s26, 16640
    s_and_b32 s27, s31, 2
    s_lshl_b32 s27, s27, 4
    s_add_u32 s26, s26, s27
    s_add_u32 s26, s26, 6553600
    v_lshrrev_b32 v6, 4, v1
    v_xor_b32 v6, v6, v1
    v_and_b32 v5, 1, v6
    v_bfe_u32 v6, v6, 1, 1
    v_lshl_add_u32 v6, v6, 2, v5
    v_lshrrev_b32 v5, 2, v1
    v_lshl_add_u32 v6, v5, 3, v6
    v_lshlrev_b32 v6, 4, v6
    s_cmp_ge_u32 s31, 320
    s_mov_b32 s68, 15906816
    s_cmov_b32 s68, 15907072
    s_and_b32 s69, s22, 15
    s_lshl_b32 s69, s69, 9
    s_add_u32 s68, s68, s69
    v_lshl_add_u32 v162, v1, 2, s68
    s_cbranch_vccnz S_B5
    s_barrier
S_B5:
S_C5:
    s_cbranch_vccnz S_B6
    s_barrier
S_B6:
S_C6:
    s_waitcnt lgkmcnt(0)
    s_cmp_lg_u32 s60, 0
    s_cbranch_scc1 ND_S
    v_mov_b32 v66, 0
    global_load_dword v67, v66, s[6:7] sc1
    s_mov_b32 s65, 20000
NL_S:
    s_waitcnt vmcnt(0)
    v_readfirstlane_b32 s60, v67
    s_nop 0
    s_cmp_lg_u32 s60, 0
    s_cbranch_scc1 ND_S
    s_sleep 2
    global_load_dword v67, v66, s[6:7] sc1
    s_sub_u32 s65, s65, 1
    s_cmp_lg_u32 s65, 0
    s_cbranch_scc1 NL_S
    s_waitcnt vmcnt(0)
ND_S:
    s_cbranch_vccnz S_B7
    s_barrier
    s_cmp_lg_u32 s30, 1
    s_cbranch_scc1 S_C7
    v_mov_b32 v163, 0
    buffer_atomic_or v163, v162, s[16:19], 0 offen sc0 sc1
S_B7:
S_C7:
    s_cbranch_vccnz S_B8
    s_barrier
S_B8:
S_C8:
    s_cbranch_vccnz S_B9
    s_barrier
    s_cmp_lg_u32 s30, 1
    s_cbranch_scc1 S_C9
    s_waitcnt vmcnt(0)
    v_cmp_ne_u32 s[66:67], s60, v163
    s_nop 0
    s_cmp_eq_u64 s[66:67], 0
    s_cbranch_scc0 S_D9
    s_mov_b32 s30, 0
    s_add_u32 m0, s53, 1024
    s_add_u32 s27, s26, 0
    buffer_load_dwordx4 v6, s[16:19], s27 offen offset:0 sc1 lds
    s_add_u32 s27, s26, 1024
    buffer_load_dwordx4 v6, s[16:19], s27 offen offset:1024 sc1 lds
    s_add_u32 s27, s26, 2048
    buffer_load_dwordx4 v6, s[16:19], s27 offen offset:2048 sc1 lds
    s_add_u32 s27, s26, 3072
    buffer_load_dwordx4 v6, s[16:19], s27 offen offset:3072 sc1 lds
    s_add_u32 m0, s53, 5120
    s_add_u32 s27, s26, 8192
    buffer_load_dwordx4 v6, s[16:19], s27 offen offset:0 sc1 lds
    s_add_u32 s27, s26, 9216
    buffer_load_dwordx4 v6, s[16:19], s27 offen offset:1024 sc1 lds
    s_add_u32 s27, s26, 10240
    buffer_load_dwordx4 v6, s[16:19], s27 offen offset:2048 sc1 lds
    s_add_u32 s27, s26, 11264
    buffer_load_dwordx4 v6, s[16:19], s27 offen offset:3072 sc1 lds
S_D9:
    s_cmp_lg_u32 s30, 1
    s_cbranch_scc1 S_C9
    v_mov_b32 v163, 0
    buffer_atomic_or v163, v162, s[16:19], 0 offen sc0 sc1
S_B9:
S_C9:
    ds_write_b64 v164, v[68:69] offset:0
    ds_write_b64 v164, v[70:71] offset:544
    ds_write_b64 v164, v[72:73] offset:1088
    ds_write_b64 v164, v[74:75] offset:1632
    ds_write_b64 v164, v[76:77] offset:2176
    ds_write_b64 v164, v[78:79] offset:2720
    ds_write_b64 v164, v[80:81] offset:3264
    ds_write_b64 v164, v[82:83] offset:3808
    ds_write_b64 v164, v[84:85] offset:4352
    ds_write_b64 v164, v[86:87] offset:4896
    ds_write_b64 v164, v[88:89] offset:5440
    ds_write_b64 v164, v[90:91] offset:5984
    ds_write_b64 v164, v[92:93] offset:6528
    ds_write_b64 v164, v[94:95] offset:7072
    ds_write_b64 v164, v[96:97] offset:7616
    ds_write_b64 v164, v[98:99] offset:8160
    s_cmp_lg_u32 s30, 1
    s_cbranch_scc1 S_U2
    s_waitcnt vmcnt(0)
    v_cmp_ne_u32 s[66:67], s60, v163
    s_nop 0
    s_cmp_eq_u64 s[66:67], 0
    s_cbranch_scc0 S_U2
    s_mov_b32 s30, 0
    s_add_u32 m0, s53, 1024
    s_add_u32 s27, s26, 0
    buffer_load_dwordx4 v6, s[16:19], s27 offen offset:0 sc1 lds
    s_add_u32 s27, s26, 1024
    buffer_load_dwordx4 v6, s[16:19], s27 offen offset:1024 sc1 lds
    s_add_u32 s27, s26, 2048
    buffer_load_dwordx4 v6, s[16:19], s27 offen offset:2048 sc1 lds
    s_add_u32 s27, s26, 3072
    buffer_load_dwordx4 v6, s[16:19], s27 offen offset:3072 sc1 lds
    s_add_u32 m0, s53, 5120
    s_add_u32 s27, s26, 8192
    buffer_load_dwordx4 v6, s[16:19], s27 offen offset:0 sc1 lds
    s_add_u32 s27, s26, 9216
    buffer_load_dwordx4 v6, s[16:19], s27 offen offset:1024 sc1 lds
    s_add_u32 s27, s26, 10240
    buffer_load_dwordx4 v6, s[16:19], s27 offen offset:2048 sc1 lds
    s_add_u32 s27, s26, 11264
    buffer_load_dwordx4 v6, s[16:19], s27 offen offset:3072 sc1 lds
S_U2:
    ds_read_b128 v[36:39], v167 offset:0
    ds_read_b128 v[40:43], v167 offset:32
    ds_read_b128 v[44:47], v167 offset:64
    ds_read_b128 v[48:51], v167 offset:96
    ds_read_b128 v[52:55], v167 offset:128
    ds_read_b128 v[56:59], v167 offset:160
    ds_read_b128 v[60:63], v167 offset:192
    ds_read_b128 v[64:67], v167 offset:224
    ds_write_b64 v166, v[100:101] offset:0
    ds_write_b64 v166, v[102:103] offset:272
    ds_write_b64 v166, v[104:105] offset:544
    ds_write_b64 v166, v[106:107] offset:816
    ds_write_b64 v165, v[108:109] offset:2176
    ds_write_b64 v165, v[110:111] offset:2448
    ds_write_b64 v164, v[112:113] offset:3264
    ds_write_b64 v164, v[114:115] offset:3808
    ds_write_b64 v4, v[116:117] offset:4352
    ds_write_b64 v4, v[118:119] offset:4624
    ds_write_b64 v4, v[120:121] offset:5440
    ds_write_b64 v4, v[122:123] offset:5712
    ds_write_b64 v4, v[124:125] offset:4896
    ds_read_b128 v[68:71], v167 offset:0
    ds_read_b128 v[72:75], v167 offset:32
    ds_read_b128 v[76:79], v167 offset:64
    ds_read_b128 v[80:83], v167 offset:96
    ds_read_b128 v[84:87], v167 offset:128
    ds_read_b128 v[88:91], v167 offset:160
    ds_read_b128 v[92:95], v167 offset:192
    ds_read_b128 v[96:99], v167 offset:224
    s_waitcnt lgkmcnt(7)
    v_mfma_f32_32x32x16_bf16 v[18:33], v[68:71], v[36:39], 0
    s_waitcnt lgkmcnt(6)
    v_mfma_f32_32x32x16_bf16 v[18:33], v[72:75], v[40:43], v[18:33]
    s_waitcnt lgkmcnt(5)
    v_mfma_f32_32x32x16_bf16 v[18:33], v[76:79], v[44:47], v[18:33]
    s_waitcnt lgkmcnt(4)
    v_mfma_f32_32x32x16_bf16 v[18:33], v[80:83], v[48:51], v[18:33]
    s_waitcnt lgkmcnt(3)
    v_mfma_f32_32x32x16_bf16 v[18:33], v[84:87], v[52:55], v[18:33]
    s_waitcnt lgkmcnt(2)
    v_mfma_f32_32x32x16_bf16 v[18:33], v[88:91], v[56:59], v[18:33]
    s_waitcnt lgkmcnt(1)
    v_mfma_f32_32x32x16_bf16 v[18:33], v[92:95], v[60:63], v[18:33]
    s_waitcnt lgkmcnt(0)
    v_mfma_f32_32x32x16_bf16 v[18:33], v[96:99], v[64:67], v[18:33]
    v_mov_b32 v2, 0
    v_mov_b32 v3, 0
    v_mov_b32 v4, 0
    v_mov_b32 v5, 0
    s_cbranch_vccnz S_NZ
    ds_write_b128 v161, v[2:5]
S_NZ:
    s_nop 6
    ds_write_b128 v149, v[18:21]
    ds_write_b64 v150, v[22:23] offset:1024
    ds_write_b64 v151, v[24:25] offset:1032
    ds_write_b32 v152, v26 offset:2048
    ds_write_b32 v152, v27 offset:2176
    ds_write_b32 v152, v28 offset:2560
    v_mov_b32 v16, 1
    s_mov_b64 exec, 1
    ds_write_b32 v147, v16 offset:0
    s_mov_b64 exec, -1
    s_mov_b32 s65, 160000
LL_Y1:
    ds_read_b32 v16, v148 offset:0
    s_waitcnt lgkmcnt(0)
    v_readfirstlane_b32 s66, v16
    s_nop 0
    s_cmp_ge_u32 s66, 1
    s_cbranch_scc1 LD_Y1
    s_sub_u32 s65, s65, 1
    s_cmp_lg_u32 s65, 0
    s_cbranch_scc1 LL_Y1
LD_Y1:
    s_lshl_b32 s29, s31, 12
    s_lshl_b32 s28, s25, 11
    s_add_u32 s29, s29, s28
    s_add_u32 s29, s29, 8949760
    ds_read_b128 v[40:43], v153 offset:0
    ds_read_b32 v44, v146 offset:0
    ds_read2_b64 v[46:49], v154 offset0:0 offset1:1
    ds_read2_b64 v[50:53], v154 offset0:64 offset1:65
    ds_read2_b64 v[54:57], v154 offset0:128 offset1:129
    ds_read_b128 v[60:63], v153 offset:8704
    ds_read_b32 v64, v146 offset:8704
    ds_read2_b64 v[66:69], v136 offset0:0 offset1:1
    ds_read2_b64 v[70:73], v136 offset0:64 offset1:65
    ds_read2_b64 v[74:77], v136 offset0:128 offset1:129
    s_waitcnt lgkmcnt(0)
    v_add_f32 v54, v54, v74
    v_add_f32 v55, v55, v75
    v_add_f32 v56, v56, v76
    v_add_f32 v50, v50, v70
    v_add_f32 v51, v51, v71
    v_add_f32 v52, v52, v72
    v_add_f32 v46, v46, v66
    v_add_f32 v47, v47, v67
    v_add_f32 v48, v48, v68
    v_add_f32 v40, v40, v60
    v_add_f32 v41, v41, v61
    v_add_f32 v42, v42, v62
    v_add_f32 v43, v43, v63
    v_add_f32 v44, v44, v64
    v_add_f32 v40, v40, v159
    s_cmp_lg_u32 s25, 0
    s_cbranch_scc1 S_X1
    v_cvt_pk_bf16_f32 v80, v56, v56
    v_cvt_pk_bf16_f32 v81, v56, v56
    v_cvt_pk_bf16_f32 v82, v55, v55
    v_cvt_pk_bf16_f32 v83, v55, v55
    v_cvt_pk_bf16_f32 v84, v55, v55
    v_cvt_pk_bf16_f32 v85, v55, v54
    v_cvt_pk_bf16_f32 v86, v54, v54
    v_cvt_pk_bf16_f32 v87, v54, v54
    v_cvt_pk_bf16_f32 v88, v52, v52
    v_cvt_pk_bf16_f32 v89, v51, v51
    v_cvt_pk_bf16_f32 v90, v51, v50
    v_cvt_pk_bf16_f32 v91, v50, v50
    v_cvt_pk_bf16_f32 v92, v48, v47
    v_cvt_pk_bf16_f32 v93, v46, v46
    v_cvt_pk_bf16_f32 v94, v43, v42
    v_cvt_pk_bf16_f32 v95, v41, v40
    s_branch S_X2
S_X1:
    v_readlane_b32 s68, v43, 63
    v_mov_b32 v49, v46
    v_writelane_b32 v44, 0, 0
    v_cvt_pk_bf16_f32 v80, v56, v56
    v_cvt_pk_bf16_f32 v81, v56, v55
    v_cvt_pk_bf16_f32 v82, v55, v55
    v_cvt_pk_bf16_f32 v83, v55, v55
    v_cvt_pk_bf16_f32 v84, v55, v55
    v_cvt_pk_bf16_f32 v85, v54, v54
    v_cvt_pk_bf16_f32 v86, v54, v54
    v_cvt_pk_bf16_f32 v87, v54, v54
    v_writelane_b32 v49, s68, 0
    v_cvt_pk_bf16_f32 v88, v52, v51
    v_cvt_pk_bf16_f32 v89, v51, v51
    v_cvt_pk_bf16_f32 v90, v50, v50
    v_cvt_pk_bf16_f32 v91, v50, v50
    v_cvt_pk_bf16_f32 v92, v47, v46
    v_cvt_pk_bf16_f32 v93, v46, v49
    v_cvt_pk_bf16_f32 v94, v42, v41
    v_cvt_pk_bf16_f32 v95, v40, v44
S_X2:
    ds_write_b128 v155, v[80:83]
    ds_write_b128 v155, v[84:87] offset:16
    ds_write_b128 v156, v[88:91]
    ds_write_b64 v157, v[92:93]
    ds_write_b64 v157, v[94:95] offset:512
    s_mov_b64 exec, 0xffff
    ds_write_b32 v158, v3 offset:8192
    s_mov_b64 exec, -1
    s_cmp_lg_u32 s30, 1
    s_cbranch_scc1 S_NU
    v_mov_b32 v163, 0
    buffer_atomic_or v163, v162, s[16:19], 0 offen sc0 sc1
    s_mov_b32 s65, 20000
PL_S:
    s_waitcnt vmcnt(0)
    v_cmp_ne_u32 s[66:67], s60, v163
    s_nop 0
    s_cmp_eq_u64 s[66:67], 0
    s_cbranch_scc1 PD_S
    s_sleep 2
    v_mov_b32 v163, 0
    buffer_atomic_or v163, v162, s[16:19], 0 offen sc0 sc1
    s_sub_u32 s65, s65, 1
    s_cmp_lg_u32 s65, 0
    s_cbranch_scc1 PL_S
    s_waitcnt vmcnt(0)
PD_S:
    s_add_u32 m0, s53, 1024
    s_add_u32 s27, s26, 0
    buffer_load_dwordx4 v6, s[16:19], s27 offen offset:0 sc1 lds
    s_add_u32 s27, s26, 1024
    buffer_load_dwordx4 v6, s[16:19], s27 offen offset:1024 sc1 lds
    s_add_u32 s27, s26, 2048
    buffer_load_dwordx4 v6, s[16:19], s27 offen offset:2048 sc1 lds
    s_add_u32 s27, s26, 3072
    buffer_load_dwordx4 v6, s[16:19], s27 offen offset:3072 sc1 lds
    s_add_u32 m0, s53, 5120
    s_add_u32 s27, s26, 8192
    buffer_load_dwordx4 v6, s[16:19], s27 offen offset:0 sc1 lds
    s_add_u32 s27, s26, 9216
    buffer_load_dwordx4 v6, s[16:19], s27 offen offset:1024 sc1 lds
    s_add_u32 s27, s26, 10240
    buffer_load_dwordx4 v6, s[16:19], s27 offen offset:2048 sc1 lds
    s_add_u32 s27, s26, 11264
    buffer_load_dwordx4 v6, s[16:19], s27 offen offset:3072 sc1 lds
S_NU:
    s_waitcnt vmcnt(0)
    v_mov_b32 v16, 2
    s_mov_b64 exec, 1
    ds_write_b32 v147, v16 offset:0
    s_mov_b64 exec, -1
    s_mov_b32 s65, 160000
LL_Y2:
    ds_read_b32 v16, v9 offset:0
    s_waitcnt lgkmcnt(0)
    v_cmp_gt_u32 s[66:67], 2, v16
    s_nop 0
    s_cmp_eq_u64 s[66:67], 0
    s_cbranch_scc1 LD_Y2
    s_sub_u32 s65, s65, 1
    s_cmp_lg_u32 s65, 0
    s_cbranch_scc1 LL_Y2
LD_Y2:
    s_setprio 3
    s_cbranch_vccz S_PR
    s_cmp_ge_u32 s20, 4
    s_cbranch_scc1 S_PR
    s_setprio 2
S_PR:
    ds_read2_b32 v[34:35], v140 offset0:176 offset1:177
    ds_read2_b32 v[36:37], v140 offset0:178 offset1:179
    ds_read_b128 v[66:69], v132 offset:0
    ds_read_b128 v[70:73], v132 offset:1024
    ds_read_b128 v[74:77], v132 offset:2048
    ds_read_b128 v[78:81], v132 offset:3072
    ds_read_b128 v[82:85], v132 offset:4096
    ds_read_b128 v[86:89], v132 offset:5120
    ds_read_b128 v[90:93], v132 offset:6144
    ds_read_b128 v[94:97], v132 offset:7168
    ds_read2_b32 v[38:39], v140 offset0:48 offset1:49
    ds_read2_b32 v[40:41], v140 offset0:50 offset1:51
    ds_read2_b32 v[42:43], v141 offset0:176 offset1:177
    ds_read2_b32 v[44:45], v141 offset0:178 offset1:179
    s_waitcnt lgkmcnt(10)
    v_mfma_f32_16x16x32_bf16 v[2:5], v[34:37], v[66:69], 0
    ds_read2_b32 v[46:47], v141 offset0:48 offset1:49
    v_mfma_f32_16x16x32_bf16 v[6:9], v[34:37], v[70:73], 0
    ds_read2_b32 v[48:49], v141 offset0:50 offset1:51
    s_waitcnt lgkmcnt(10)
    v_mfma_f32_16x16x32_bf16 v[10:13], v[34:37], v[74:77], 0
    ds_read2_b32 v[50:51], v142 offset0:176 offset1:177
    v_mfma_f32_16x16x32_bf16 v[14:17], v[34:37], v[78:81], 0
    ds_read2_b32 v[52:53], v142 offset0:178 offset1:179
    s_waitcnt lgkmcnt(10)
    v_mfma_f32_16x16x32_bf16 v[18:21], v[34:37], v[82:85], 0
    ds_read2_b32 v[54:55], v142 offset0:48 offset1:49
    v_mfma_f32_16x16x32_bf16 v[22:25], v[34:37], v[86:89], 0
    ds_read2_b32 v[56:57], v142 offset0:50 offset1:51
    s_waitcnt lgkmcnt(10)
    v_mfma_f32_16x16x32_bf16 v[26:29], v[34:37], v[90:93], 0
    ds_read2_b32 v[58:59], v143 offset0:176 offset1:177
    v_mfma_f32_16x16x32_bf16 v[30:33], v[34:37], v[94:97], 0
    ds_read2_b32 v[60:61], v143 offset0:178 offset1:179
    s_waitcnt lgkmcnt(10)
    v_mfma_f32_16x16x32_bf16 v[6:9], v[38:41], v[66:69], v[6:9]
    ds_read2_b32 v[62:63], v143 offset0:48 offset1:49
    v_mfma_f32_16x16x32_bf16 v[10:13], v[38:41], v[70:73], v[10:13]
    ds_read2_b32 v[64:65], v143 offset0:50 offset1:51
    v_mfma_f32_16x16x32_bf16 v[14:17], v[38:41], v[74:77], v[14:17]
    ds_read_b128 v[98:101], v133 offset:0
    v_mfma_f32_16x16x32_bf16 v[18:21], v[38:41], v[78:81], v[18:21]
    ds_read_b128 v[102:105], v133 offset:1024
    v_mfma_f32_16x16x32_bf16 v[22:25], v[38:41], v[82:85], v[22:25]
    ds_read_b128 v[106:109], v133 offset:2048
    v_mfma_f32_16x16x32_bf16 v[26:29], v[38:41], v[86:89], v[26:29]
    ds_read_b128 v[110:113], v133 offset:3072
    v_mfma_f32_16x16x32_bf16 v[30:33], v[38:41], v[90:93], v[30:33]
    ds_read_b128 v[114:117], v133 offset:4096
    s_waitcnt lgkmcnt(10)
    v_mfma_f32_16x16x32_bf16 v[10:13], v[42:45], v[66:69], v[10:13]
    ds_read_b128 v[118:121], v133 offset:5120
    v_mfma_f32_16x16x32_bf16 v[14:17], v[42:45], v[70:73], v[14:17]
    ds_read_b128 v[122:125], v133 offset:6144
    v_mfma_f32_16x16x32_bf16 v[18:21], v[42:45], v[74:77], v[18:21]
    ds_read_b128 v[126:129], v133 offset:7168
    v_mfma_f32_16x16x32_bf16 v[22:25], v[42:45], v[78:81], v[22:25]
    ds_read2_b32 v[34:35], v140 offset0:160 offset1:161
    v_mfma_f32_16x16x32_bf16 v[26:29], v[42:45], v[82:85], v[26:29]
    ds_read2_b32 v[36:37], v140 offset0:162 offset1:163
    v_mfma_f32_16x16x32_bf16 v[30:33], v[42:45], v[86:89], v[30:33]
    ds_read2_b32 v[38:39], v140 offset0:32 offset1:33
    v_mfma_f32_16x16x32_bf16 v[14:17], v[46:49], v[66:69], v[14:17]
    ds_read2_b32 v[40:41], v140 offset0:34 offset1:35
    v_mfma_f32_16x16x32_bf16 v[18:21], v[46:49], v[70:73], v[18:21]
    ds_read2_b32 v[42:43], v141 offset0:160 offset1:161
    v_mfma_f32_16x16x32_bf16 v[22:25], v[46:49], v[74:77], v[22:25]
    ds_read2_b32 v[44:45], v141 offset0:162 offset1:163
    v_mfma_f32_16x16x32_bf16 v[26:29], v[46:49], v[78:81], v[26:29]
    v_mfma_f32_16x16x32_bf16 v[30:33], v[46:49], v[82:85], v[30:33]
    v_mfma_f32_16x16x32_bf16 v[18:21], v[50:53], v[66:69], v[18:21]
    ds_read2_b32 v[46:47], v141 offset0:32 offset1:33
    v_mfma_f32_16x16x32_bf16 v[22:25], v[50:53], v[70:73], v[22:25]
    ds_read2_b32 v[48:49], v141 offset0:34 offset1:35
    v_mfma_f32_16x16x32_bf16 v[26:29], v[50:53], v[74:77], v[26:29]
    v_mfma_f32_16x16x32_bf16 v[30:33], v[50:53], v[78:81], v[30:33]
    s_waitcnt lgkmcnt(10)
    v_mfma_f32_16x16x32_bf16 v[22:25], v[54:57], v[66:69], v[22:25]
    ds_read2_b32 v[50:51], v142 offset0:160 offset1:161
    v_mfma_f32_16x16x32_bf16 v[26:29], v[54:57], v[70:73], v[26:29]
    ds_read2_b32 v[52:53], v142 offset0:162 offset1:163
    v_mfma_f32_16x16x32_bf16 v[30:33], v[54:57], v[74:77], v[30:33]
    v_mfma_f32_16x16x32_bf16 v[26:29], v[58:61], v[66:69], v[26:29]
    ds_read2_b32 v[54:55], v142 offset0:32 offset1:33
    v_mfma_f32_16x16x32_bf16 v[30:33], v[58:61], v[70:73], v[30:33]
    ds_read2_b32 v[56:57], v142 offset0:34 offset1:35
    v_mfma_f32_16x16x32_bf16 v[30:33], v[62:65], v[66:69], v[30:33]
    ds_read2_b32 v[58:59], v143 offset0:160 offset1:161
    s_waitcnt lgkmcnt(10)
    v_mfma_f32_16x16x32_bf16 v[2:5], v[34:37], v[98:101], v[2:5]
    ds_read2_b32 v[60:61], v143 offset0:162 offset1:163
    v_mfma_f32_16x16x32_bf16 v[6:9], v[34:37], v[102:105], v[6:9]
    ds_read2_b32 v[62:63], v143 offset0:32 offset1:33
    v_mfma_f32_16x16x32_bf16 v[10:13], v[34:37], v[106:109], v[10:13]
    ds_read2_b32 v[64:65], v143 offset0:34 offset1:35
    v_mfma_f32_16x16x32_bf16 v[14:17], v[34:37], v[110:113], v[14:17]
    ds_read_b128 v[66:69], v134 offset:0
    v_mfma_f32_16x16x32_bf16 v[18:21], v[34:37], v[114:117], v[18:21]
    ds_read_b128 v[70:73], v134 offset:1024
    v_mfma_f32_16x16x32_bf16 v[22:25], v[34:37], v[118:121], v[22:25]
    ds_read_b128 v[74:77], v134 offset:2048
    v_mfma_f32_16x16x32_bf16 v[26:29], v[34:37], v[122:125], v[26:29]
    ds_read_b128 v[78:81], v134 offset:3072
    v_mfma_f32_16x16x32_bf16 v[30:33], v[34:37], v[126:129], v[30:33]
    ds_read_b128 v[82:85], v134 offset:4096
    s_waitcnt lgkmcnt(10)
    v_mfma_f32_16x16x32_bf16 v[6:9], v[38:41], v[98:101], v[6:9]
    ds_read_b128 v[86:89], v134 offset:5120
    v_mfma_f32_16x16x32_bf16 v[10:13], v[38:41], v[102:105], v[10:13]
    ds_read_b128 v[90:93], v134 offset:6144
    v_mfma_f32_16x16x32_bf16 v[14:17], v[38:41], v[106:109], v[14:17]
    ds_read_b128 v[94:97], v134 offset:7168
    v_mfma_f32_16x16x32_bf16 v[18:21], v[38:41], v[110:113], v[18:21]
    ds_read2_b32 v[34:35], v140 offset0:144 offset1:145
    v_mfma_f32_16x16x32_bf16 v[22:25], v[38:41], v[114:117], v[22:25]
    ds_read2_b32 v[36:37], v140 offset0:146 offset1:147
    v_mfma_f32_16x16x32_bf16 v[26:29], v[38:41], v[118:121], v[26:29]
    v_mfma_f32_16x16x32_bf16 v[30:33], v[38:41], v[122:125], v[30:33]
    v_mfma_f32_16x16x32_bf16 v[10:13], v[42:45], v[98:101], v[10:13]
    ds_read2_b32 v[38:39], v140 offset0:16 offset1:17
    v_mfma_f32_16x16x32_bf16 v[14:17], v[42:45], v[102:105], v[14:17]
    ds_read2_b32 v[40:41], v140 offset0:18 offset1:19
    v_mfma_f32_16x16x32_bf16 v[18:21], v[42:45], v[106:109], v[18:21]
    v_mfma_f32_16x16x32_bf16 v[22:25], v[42:45], v[110:113], v[22:25]
    v_mfma_f32_16x16x32_bf16 v[26:29], v[42:45], v[114:117], v[26:29]
    v_mfma_f32_16x16x32_bf16 v[30:33], v[42:45], v[118:121], v[30:33]
    v_mfma_f32_16x16x32_bf16 v[14:17], v[46:49], v[98:101], v[14:17]
    ds_read2_b32 v[42:43], v141 offset0:144 offset1:145
    v_mfma_f32_16x16x32_bf16 v[18:21], v[46:49], v[102:105], v[18:21]
    ds_read2_b32 v[44:45], v141 offset0:146 offset1:147
    v_mfma_f32_16x16x32_bf16 v[22:25], v[46:49], v[106:109], v[22:25]
    v_mfma_f32_16x16x32_bf16 v[26:29], v[46:49], v[110:113], v[26:29]
    v_mfma_f32_16x16x32_bf16 v[30:33], v[46:49], v[114:117], v[30:33]
    v_mfma_f32_16x16x32_bf16 v[18:21], v[50:53], v[98:101], v[18:21]
    ds_read2_b32 v[46:47], v141 offset0:16 offset1:17
    v_mfma_f32_16x16x32_bf16 v[22:25], v[50:53], v[102:105], v[22:25]
    ds_read2_b32 v[48:49], v141 offset0:18 offset1:19
    v_mfma_f32_16x16x32_bf16 v[26:29], v[50:53], v[106:109], v[26:29]
    v_mfma_f32_16x16x32_bf16 v[30:33], v[50:53], v[110:113], v[30:33]
    s_waitcnt lgkmcnt(10)
    v_mfma_f32_16x16x32_bf16 v[22:25], v[54:57], v[98:101], v[22:25]
    ds_read2_b32 v[50:51], v142 offset0:144 offset1:145
    v_mfma_f32_16x16x32_bf16 v[26:29], v[54:57], v[102:105], v[26:29]
    ds_read2_b32 v[52:53], v142 offset0:146 offset1:147
    v_mfma_f32_16x16x32_bf16 v[30:33], v[54:57], v[106:109], v[30:33]
    v_mfma_f32_16x16x32_bf16 v[26:29], v[58:61], v[98:101], v[26:29]
    ds_read2_b32 v[54:55], v142 offset0:16 offset1:17
    v_mfma_f32_16x16x32_bf16 v[30:33], v[58:61], v[102:105], v[30:33]
    ds_read2_b32 v[56:57], v142 offset0:18 offset1:19
    v_mfma_f32_16x16x32_bf16 v[30:33], v[62:65], v[98:101], v[30:33]
    ds_read2_b32 v[58:59], v143 offset0:144 offset1:145
    s_waitcnt lgkmcnt(10)
    v_mfma_f32_16x16x32_bf16 v[2:5], v[34:37], v[66:69], v[2:5]
    ds_read2_b32 v[60:61], v143 offset0:146 offset1:147
    v_mfma_f32_16x16x32_bf16 v[6:9], v[34:37], v[70:73], v[6:9]
    ds_read2_b32 v[62:63], v143 offset0:16 offset1:17
    v_mfma_f32_16x16x32_bf16 v[10:13], v[34:37], v[74:77], v[10:13]
    ds_read2_b32 v[64:65], v143 offset0:18 offset1:19
    v_mfma_f32_16x16x32_bf16 v[14:17], v[34:37], v[78:81], v[14:17]
    ds_read_b128 v[98:101], v135 offset:0
    v_mfma_f32_16x16x32_bf16 v[18:21], v[34:37], v[82:85], v[18:21]
    ds_read_b128 v[102:105], v135 offset:1024
    v_mfma_f32_16x16x32_bf16 v[22:25], v[34:37], v[86:89], v[22:25]
    ds_read_b128 v[106:109], v135 offset:2048
    v_mfma_f32_16x16x32_bf16 v[26:29], v[34:37], v[90:93], v[26:29]
    ds_read_b128 v[110:113], v135 offset:3072
    v_mfma_f32_16x16x32_bf16 v[30:33], v[34:37], v[94:97], v[30:33]
    ds_read_b128 v[114:117], v135 offset:4096
    s_waitcnt lgkmcnt(10)
    v_mfma_f32_16x16x32_bf16 v[6:9], v[38:41], v[66:69], v[6:9]
    ds_read_b128 v[118:121], v135 offset:5120
    v_mfma_f32_16x16x32_bf16 v[10:13], v[38:41], v[70:73], v[10:13]
    ds_read_b128 v[122:125], v135 offset:6144
    v_mfma_f32_16x16x32_bf16 v[14:17], v[38:41], v[74:77], v[14:17]
    ds_read_b128 v[126:129], v135 offset:7168
    v_mfma_f32_16x16x32_bf16 v[18:21], v[38:41], v[78:81], v[18:21]
    ds_read2_b32 v[34:35], v140 offset0:128 offset1:129
    v_mfma_f32_16x16x32_bf16 v[22:25], v[38:41], v[82:85], v[22:25]
    ds_read2_b32 v[36:37], v140 offset0:130 offset1:131
    v_mfma_f32_16x16x32_bf16 v[26:29], v[38:41], v[86:89], v[26:29]
    v_mfma_f32_16x16x32_bf16 v[30:33], v[38:41], v[90:93], v[30:33]
    v_mfma_f32_16x16x32_bf16 v[10:13], v[42:45], v[66:69], v[10:13]
    ds_read2_b32 v[38:39], v140 offset0:0 offset1:1
    v_mfma_f32_16x16x32_bf16 v[14:17], v[42:45], v[70:73], v[14:17]
    ds_read2_b32 v[40:41], v140 offset0:2 offset1:3
    v_mfma_f32_16x16x32_bf16 v[18:21], v[42:45], v[74:77], v[18:21]
    v_mfma_f32_16x16x32_bf16 v[22:25], v[42:45], v[78:81], v[22:25]
    v_mfma_f32_16x16x32_bf16 v[26:29], v[42:45], v[82:85], v[26:29]
    v_mfma_f32_16x16x32_bf16 v[30:33], v[42:45], v[86:89], v[30:33]
    v_mfma_f32_16x16x32_bf16 v[14:17], v[46:49], v[66:69], v[14:17]
    ds_read2_b32 v[42:43], v141 offset0:128 offset1:129
    v_mfma_f32_16x16x32_bf16 v[18:21], v[46:49], v[70:73], v[18:21]
    ds_read2_b32 v[44:45], v141 offset0:130 offset1:131
    v_mfma_f32_16x16x32_bf16 v[22:25], v[46:49], v[74:77], v[22:25]
    v_mfma_f32_16x16x32_bf16 v[26:29], v[46:49], v[78:81], v[26:29]
    v_mfma_f32_16x16x32_bf16 v[30:33], v[46:49], v[82:85], v[30:33]
    v_mfma_f32_16x16x32_bf16 v[18:21], v[50:53], v[66:69], v[18:21]
    ds_read2_b32 v[46:47], v141 offset0:0 offset1:1
    v_mfma_f32_16x16x32_bf16 v[22:25], v[50:53], v[70:73], v[22:25]
    ds_read2_b32 v[48:49], v141 offset0:2 offset1:3
    v_mfma_f32_16x16x32_bf16 v[26:29], v[50:53], v[74:77], v[26:29]
    v_mfma_f32_16x16x32_bf16 v[30:33], v[50:53], v[78:81], v[30:33]
    s_waitcnt lgkmcnt(10)
    v_mfma_f32_16x16x32_bf16 v[22:25], v[54:57], v[66:69], v[22:25]
    ds_read2_b32 v[50:51], v142 offset0:128 offset1:129
    v_mfma_f32_16x16x32_bf16 v[26:29], v[54:57], v[70:73], v[26:29]
    ds_read2_b32 v[52:53], v142 offset0:130 offset1:131
    v_mfma_f32_16x16x32_bf16 v[30:33], v[54:57], v[74:77], v[30:33]
    v_mfma_f32_16x16x32_bf16 v[26:29], v[58:61], v[66:69], v[26:29]
    ds_read2_b32 v[54:55], v142 offset0:0 offset1:1
    v_mfma_f32_16x16x32_bf16 v[30:33], v[58:61], v[70:73], v[30:33]
    ds_read2_b32 v[56:57], v142 offset0:2 offset1:3
    v_mfma_f32_16x16x32_bf16 v[30:33], v[62:65], v[66:69], v[30:33]
    ds_read2_b32 v[58:59], v143 offset0:128 offset1:129
    ds_read2_b32 v[60:61], v143 offset0:130 offset1:131
    ds_read2_b32 v[62:63], v143 offset0:0 offset1:1
    ds_read2_b32 v[64:65], v143 offset0:2 offset1:3
    s_cmp_lg_u32 s25, 0
    s_cbranch_scc1 S_E1
    s_waitcnt lgkmcnt(10)
    v_mfma_f32_16x16x32_bf16 v[18:21], v[34:37], v[114:117], v[18:21]
    v_mfma_f32_16x16x32_bf16 v[22:25], v[34:37], v[118:121], v[22:25]
    v_mfma_f32_16x16x32_bf16 v[26:29], v[34:37], v[122:125], v[26:29]
    v_mfma_f32_16x16x32_bf16 v[30:33], v[34:37], v[126:129], v[30:33]
    v_mfma_f32_16x16x32_bf16 v[18:21], v[38:41], v[110:113], v[18:21]
    v_mfma_f32_16x16x32_bf16 v[22:25], v[38:41], v[114:117], v[22:25]
    v_mfma_f32_16x16x32_bf16 v[26:29], v[38:41], v[118:121], v[26:29]
    v_mfma_f32_16x16x32_bf16 v[30:33], v[38:41], v[122:125], v[30:33]
    v_mfma_f32_16x16x32_bf16 v[18:21], v[42:45], v[106:109], v[18:21]
    v_mfma_f32_16x16x32_bf16 v[22:25], v[42:45], v[110:113], v[22:25]
    v_mfma_f32_16x16x32_bf16 v[26:29], v[42:45], v[114:117], v[26:29]
    v_mfma_f32_16x16x32_bf16 v[30:33], v[42:45], v[118:121], v[30:33]
    s_waitcnt lgkmcnt(8)
    v_mfma_f32_16x16x32_bf16 v[18:21], v[46:49], v[102:105], v[18:21]
    v_mfma_f32_16x16x32_bf16 v[22:25], v[46:49], v[106:109], v[22:25]
    v_mfma_f32_16x16x32_bf16 v[26:29], v[46:49], v[110:113], v[26:29]
    v_mfma_f32_16x16x32_bf16 v[30:33], v[46:49], v[114:117], v[30:33]
    s_waitcnt lgkmcnt(6)
    v_mfma_f32_16x16x32_bf16 v[18:21], v[50:53], v[98:101], v[18:21]
    v_mfma_f32_16x16x32_bf16 v[22:25], v[50:53], v[102:105], v[22:25]
    v_mfma_f32_16x16x32_bf16 v[26:29], v[50:53], v[106:109], v[26:29]
    v_mfma_f32_16x16x32_bf16 v[30:33], v[50:53], v[110:113], v[30:33]
    s_waitcnt lgkmcnt(4)
    v_mfma_f32_16x16x32_bf16 v[22:25], v[54:57], v[98:101], v[22:25]
    v_mfma_f32_16x16x32_bf16 v[26:29], v[54:57], v[102:105], v[26:29]
    v_mfma_f32_16x16x32_bf16 v[30:33], v[54:57], v[106:109], v[30:33]
    s_waitcnt lgkmcnt(2)
    v_mfma_f32_16x16x32_bf16 v[26:29], v[58:61], v[98:101], v[26:29]
    v_mfma_f32_16x16x32_bf16 v[30:33], v[58:61], v[102:105], v[30:33]
    s_waitcnt lgkmcnt(0)
    v_mfma_f32_16x16x32_bf16 v[30:33], v[62:65], v[98:101], v[30:33]
    v_mfma_f32_16x16x32_bf16 v[2:5], v[34:37], v[98:101], v[2:5]
    v_mfma_f32_16x16x32_bf16 v[6:9], v[34:37], v[102:105], v[6:9]
    v_mfma_f32_16x16x32_bf16 v[10:13], v[34:37], v[106:109], v[10:13]
    v_mfma_f32_16x16x32_bf16 v[14:17], v[34:37], v[110:113], v[14:17]
    v_mfma_f32_16x16x32_bf16 v[6:9], v[38:41], v[98:101], v[6:9]
    ds_write_b128 v160, v[18:21] offset:0
    v_mfma_f32_16x16x32_bf16 v[10:13], v[38:41], v[102:105], v[10:13]
    ds_write_b128 v160, v[22:25] offset:1024
    v_mfma_f32_16x16x32_bf16 v[14:17], v[38:41], v[106:109], v[14:17]
    ds_write_b128 v160, v[26:29] offset:2048
    v_mfma_f32_16x16x32_bf16 v[10:13], v[42:45], v[98:101], v[10:13]
    ds_write_b128 v160, v[30:33] offset:3072
    v_mfma_f32_16x16x32_bf16 v[14:17], v[42:45], v[102:105], v[14:17]
    v_mov_b32 v132, 3
    s_mov_b64 exec, 1
    ds_write_b32 v147, v132 offset:0
    s_mov_b64 exec, -1
    v_mfma_f32_16x16x32_bf16 v[14:17], v[46:49], v[98:101], v[14:17]
    s_mov_b32 s65, 160000
LL_Y30:
    ds_read_b32 v132, v148 offset:0
    s_waitcnt lgkmcnt(0)
    v_readfirstlane_b32 s66, v132
    s_nop 0
    s_cmp_ge_u32 s66, 3
    s_cbranch_scc1 LD_Y30
    s_sub_u32 s65, s65, 1
    s_cmp_lg_u32 s65, 0
    s_cbranch_scc1 LL_Y30
LD_Y30:
    ds_read_b128 v[66:69], v153 offset:8704
    ds_read_b128 v[70:73], v153 offset:9728
    ds_read_b128 v[74:77], v153 offset:10752
    ds_read_b128 v[78:81], v153 offset:11776
    v_mov_b32 v132, 4
    s_mov_b64 exec, 1
    ds_write_b32 v147, v132 offset:0
    s_mov_b64 exec, -1
    s_waitcnt lgkmcnt(4)
    v_add_f32 v2, v2, v66
    v_add_f32 v3, v3, v67
    v_add_f32 v4, v4, v68
    v_add_f32 v5, v5, v69
    v_cvt_pk_bf16_f32 v84, v2, v3
    v_cvt_pk_bf16_f32 v85, v4, v5
    buffer_store_dwordx2 v[84:85], v145, s[16:19], s29 offen offset:0 sc1
    s_waitcnt lgkmcnt(3)
    v_add_f32 v6, v6, v70
    v_add_f32 v7, v7, v71
    v_add_f32 v8, v8, v72
    v_add_f32 v9, v9, v73
    v_cvt_pk_bf16_f32 v86, v6, v7
    v_cvt_pk_bf16_f32 v87, v8, v9
    buffer_store_dwordx2 v[86:87], v145, s[16:19], s29 offen offset:512 sc1
    s_waitcnt lgkmcnt(2)
    v_add_f32 v10, v10, v74
    v_add_f32 v11, v11, v75
    v_add_f32 v12, v12, v76
    v_add_f32 v13, v13, v77
    v_cvt_pk_bf16_f32 v88, v10, v11
    v_cvt_pk_bf16_f32 v89, v12, v13
    buffer_store_dwordx2 v[88:89], v145, s[16:19], s29 offen offset:1024 sc1
    s_waitcnt lgkmcnt(1)
    v_add_f32 v14, v14, v78
    v_add_f32 v15, v15, v79
    v_add_f32 v16, v16, v80
    v_add_f32 v17, v17, v81
    v_cvt_pk_bf16_f32 v90, v14, v15
    v_cvt_pk_bf16_f32 v91, v16, v17
    buffer_store_dwordx2 v[90:91], v145, s[16:19], s29 offen offset:1536 sc1
    s_cmp_ge_u32 s20, 4
    s_cbranch_scc1 F_ATT
    s_cmp_eq_u32 s20, 0
    s_cbranch_scc1 F_D
    s_setprio 0
    s_waitcnt vmcnt(0)
    v_mov_b32 v132, 5
    s_mov_b64 exec, 1
    ds_write_b32 v147, v132 offset:0
    s_mov_b64 exec, -1
    s_waitcnt lgkmcnt(0)
    s_branch S_OUT
S_E1:
    s_waitcnt lgkmcnt(10)
    v_mfma_f32_16x16x32_bf16 v[2:5], v[34:37], v[98:101], v[2:5]
    v_mfma_f32_16x16x32_bf16 v[6:9], v[34:37], v[102:105], v[6:9]
    v_mfma_f32_16x16x32_bf16 v[10:13], v[34:37], v[106:109], v[10:13]
    v_mfma_f32_16x16x32_bf16 v[14:17], v[34:37], v[110:113], v[14:17]
    v_mfma_f32_16x16x32_bf16 v[6:9], v[38:41], v[98:101], v[6:9]
    v_mfma_f32_16x16x32_bf16 v[10:13], v[38:41], v[102:105], v[10:13]
    v_mfma_f32_16x16x32_bf16 v[14:17], v[38:41], v[106:109], v[14:17]
    v_mfma_f32_16x16x32_bf16 v[10:13], v[42:45], v[98:101], v[10:13]
    v_mfma_f32_16x16x32_bf16 v[14:17], v[42:45], v[102:105], v[14:17]
    s_waitcnt lgkmcnt(8)
    v_mfma_f32_16x16x32_bf16 v[14:17], v[46:49], v[98:101], v[14:17]
    v_mfma_f32_16x16x32_bf16 v[18:21], v[34:37], v[114:117], v[18:21]
    v_mfma_f32_16x16x32_bf16 v[22:25], v[34:37], v[118:121], v[22:25]
    v_mfma_f32_16x16x32_bf16 v[26:29], v[34:37], v[122:125], v[26:29]
    v_mfma_f32_16x16x32_bf16 v[30:33], v[34:37], v[126:129], v[30:33]
    v_mfma_f32_16x16x32_bf16 v[18:21], v[38:41], v[110:113], v[18:21]
    ds_write_b128 v160, v[2:5] offset:0
    v_mfma_f32_16x16x32_bf16 v[22:25], v[38:41], v[114:117], v[22:25]
    ds_write_b128 v160, v[6:9] offset:1024
    v_mfma_f32_16x16x32_bf16 v[26:29], v[38:41], v[118:121], v[26:29]
    ds_write_b128 v160, v[10:13] offset:2048
    v_mfma_f32_16x16x32_bf16 v[30:33], v[38:41], v[122:125], v[30:33]
    ds_write_b128 v160, v[14:17] offset:3072
    v_mfma_f32_16x16x32_bf16 v[18:21], v[42:45], v[106:109], v[18:21]
    v_mov_b32 v132, 3
    s_mov_b64 exec, 1
    ds_write_b32 v147, v132 offset:0
    s_mov_b64 exec, -1
    v_mfma_f32_16x16x32_bf16 v[22:25], v[42:45], v[110:113], v[22:25]
    v_mfma_f32_16x16x32_bf16 v[26:29], v[42:45], v[114:117], v[26:29]
    v_mfma_f32_16x16x32_bf16 v[30:33], v[42:45], v[118:121], v[30:33]
    v_mfma_f32_16x16x32_bf16 v[18:21], v[46:49], v[102:105], v[18:21]
    v_mfma_f32_16x16x32_bf16 v[22:25], v[46:49], v[106:109], v[22:25]
    v_mfma_f32_16x16x32_bf16 v[26:29], v[46:49], v[110:113], v[26:29]
    v_mfma_f32_16x16x32_bf16 v[30:33], v[46:49], v[114:117], v[30:33]
    s_waitcnt lgkmcnt(10)
    v_mfma_f32_16x16x32_bf16 v[18:21], v[50:53], v[98:101], v[18:21]
    v_mfma_f32_16x16x32_bf16 v[22:25], v[50:53], v[102:105], v[22:25]
    v_mfma_f32_16x16x32_bf16 v[26:29], v[50:53], v[106:109], v[26:29]
    v_mfma_f32_16x16x32_bf16 v[30:33], v[50:53], v[110:113], v[30:33]
    s_waitcnt lgkmcnt(9)
    v_mfma_f32_16x16x32_bf16 v[22:25], v[54:57], v[98:101], v[22:25]
    v_mfma_f32_16x16x32_bf16 v[26:29], v[54:57], v[102:105], v[26:29]
    v_mfma_f32_16x16x32_bf16 v[30:33], v[54:57], v[106:109], v[30:33]
    s_waitcnt lgkmcnt(7)
    v_mfma_f32_16x16x32_bf16 v[26:29], v[58:61], v[98:101], v[26:29]
    v_mfma_f32_16x16x32_bf16 v[30:33], v[58:61], v[102:105], v[30:33]
    s_waitcnt lgkmcnt(5)
    v_mfma_f32_16x16x32_bf16 v[30:33], v[62:65], v[98:101], v[30:33]
    s_mov_b32 s65, 160000
LL_Y31:
    ds_read_b32 v132, v148 offset:0
    s_waitcnt lgkmcnt(0)
    v_readfirstlane_b32 s66, v132
    s_nop 0
    s_cmp_ge_u32 s66, 3
    s_cbranch_scc1 LD_Y31
    s_sub_u32 s65, s65, 1
    s_cmp_lg_u32 s65, 0
    s_cbranch_scc1 LL_Y31
LD_Y31:
    ds_read_b128 v[66:69], v153 offset:0
    ds_read_b128 v[70:73], v153 offset:1024
    ds_read_b128 v[74:77], v153 offset:2048
    ds_read_b128 v[78:81], v153 offset:3072
    v_mov_b32 v132, 4
    s_mov_b64 exec, 1
    ds_write_b32 v147, v132 offset:0
    s_mov_b64 exec, -1
    s_waitcnt lgkmcnt(4)
    v_add_f32 v18, v18, v66
    v_add_f32 v19, v19, v67
    v_add_f32 v20, v20, v68
    v_add_f32 v21, v21, v69
    v_cvt_pk_bf16_f32 v84, v18, v19
    v_cvt_pk_bf16_f32 v85, v20, v21
    buffer_store_dwordx2 v[84:85], v145, s[16:19], s29 offen offset:0 sc1
    s_waitcnt lgkmcnt(3)
    v_add_f32 v22, v22, v70
    v_add_f32 v23, v23, v71
    v_add_f32 v24, v24, v72
    v_add_f32 v25, v25, v73
    v_cvt_pk_bf16_f32 v86, v22, v23
    v_cvt_pk_bf16_f32 v87, v24, v25
    buffer_store_dwordx2 v[86:87], v145, s[16:19], s29 offen offset:512 sc1
    s_waitcnt lgkmcnt(2)
    v_add_f32 v26, v26, v74
    v_add_f32 v27, v27, v75
    v_add_f32 v28, v28, v76
    v_add_f32 v29, v29, v77
    v_cvt_pk_bf16_f32 v88, v26, v27
    v_cvt_pk_bf16_f32 v89, v28, v29
    buffer_store_dwordx2 v[88:89], v145, s[16:19], s29 offen offset:1024 sc1
    s_waitcnt lgkmcnt(1)
    v_add_f32 v30, v30, v78
    v_add_f32 v31, v31, v79
    v_add_f32 v32, v32, v80
    v_add_f32 v33, v33, v81
    v_cvt_pk_bf16_f32 v90, v30, v31
    v_cvt_pk_bf16_f32 v91, v32, v33
    buffer_store_dwordx2 v[90:91], v145, s[16:19], s29 offen offset:1536 sc1
    s_cmp_ge_u32 s20, 4
    s_cbranch_scc1 F_ATT
    s_setprio 0
    s_waitcnt vmcnt(0)
    s_lshl_b32 s28, s31, 7
    s_add_u32 s28, s28, 15800320
    s_mov_b32 s65, 160000
LL_Y5:
    ds_read_b32 v132, v148 offset:0
    s_waitcnt lgkmcnt(0)
    v_readfirstlane_b32 s66, v132
    s_nop 0
    s_cmp_ge_u32 s66, 5
    s_cbranch_scc1 LD_Y5
    s_sleep 1
    s_sub_u32 s65, s65, 1
    s_cmp_lg_u32 s65, 0
    s_cbranch_scc1 LL_Y5
LD_Y5:
    v_mov_b32 v132, 0
    v_mov_b32 v133, s60
    s_mov_b64 exec, 1
    buffer_atomic_swap v133, v132, s[16:19], s28 offen sc1
    s_mov_b64 exec, -1
S_OUT:
    s_endpgm
F_TR:
    s_setprio 3
    s_lshl_b32 s23, s21, 2
    s_add_u32 s23, s23, s22
    s_sub_u32 s23, s23, 28
    v_and_b32 v3, 7, v1
    v_lshlrev_b32 v4, 4, v3
    v_lshrrev_b32 v7, 3, v1
    s_and_b32 s30, s20, 1
    s_bfe_u32 s31, s20, 0x10001
    s_lshl_b32 s48, s23, 1
    s_add_u32 s48, s48, s30
    s_mul_i32 s49, s48, 36864
    s_lshl_b32 s50, s31, 9
    s_add_u32 s49, s49, s50
    s_mul_i32 s50, s30, 20480
    s_mul_i32 s52, s30, 16384
    s_add_u32 s52, s52, 36864
    s_cmp_eq_u32 s31, 0
    s_cselect_b32 s50, s50, s52
    s_mul_i32 s51, s31, 1064960
    s_lshl_b32 s52, s48, 8
    s_add_u32 s51, s51, s52
    s_add_u32 s51, s51, 6553600
    v_bfe_u32 v9, v1, 4, 1
    v_lshlrev_b32 v9, 4, v9
    v_xor_b32 v14, v9, v4
    v_mul_u32_u24 v9, 1152, v7
    v_xor_b32 v15, 32, v14
    v_xor_b32 v16, 64, v14
    v_xor_b32 v17, 96, v14
    v_add_u32 v14, v14, v9
    v_add_u32 v15, v15, v9
    v_add_u32 v16, v16, v9
    v_add_u32 v17, v17, v9
    s_waitcnt lgkmcnt(0)
    s_add_u32 m0, s50, 16384
    s_add_u32 s52, s49, 512
    buffer_load_dwordx4 v14, s[8:11], s52 offen offset:0  lds
    s_add_u32 s52, s49, 8704
    buffer_load_dwordx4 v15, s[8:11], s52 offen offset:1024  lds
    s_add_u32 s52, s49, 16896
    buffer_load_dwordx4 v16, s[8:11], s52 offen offset:2048  lds
    s_add_u32 s52, s49, 25088
    buffer_load_dwordx4 v17, s[8:11], s52 offen offset:3072  lds
    s_add_u32 m0, s50, 12288
    s_add_u32 s52, s49, 384
    buffer_load_dwordx4 v14, s[8:11], s52 offen offset:0  lds
    s_add_u32 s52, s49, 8576
    buffer_load_dwordx4 v15, s[8:11], s52 offen offset:1024  lds
    s_add_u32 s52, s49, 16768
    buffer_load_dwordx4 v16, s[8:11], s52 offen offset:2048  lds
    s_add_u32 s52, s49, 24960
    buffer_load_dwordx4 v17, s[8:11], s52 offen offset:3072  lds
    s_barrier
    s_add_u32 m0, s50, 8192
    s_add_u32 s52, s49, 256
    buffer_load_dwordx4 v14, s[8:11], s52 offen offset:0  lds
    s_add_u32 s52, s49, 8448
    buffer_load_dwordx4 v15, s[8:11], s52 offen offset:1024  lds
    s_add_u32 s52, s49, 16640
    buffer_load_dwordx4 v16, s[8:11], s52 offen offset:2048  lds
    s_add_u32 s52, s49, 24832
    buffer_load_dwordx4 v17, s[8:11], s52 offen offset:3072  lds
    v_bfe_u32 v9, v1, 2, 2
    v_and_b32 v10, 3, v1
    v_lshl_add_u32 v11, v10, 3, v9
    v_lshlrev_b32 v11, 7, v11
    v_bfe_u32 v18, v1, 4, 1
    v_lshl_add_u32 v11, v18, 3, v11
    v_add_u32 v11, s50, v11
    v_lshrrev_b32 v18, 1, v9
    v_lshl_or_b32 v18, v10, 1, v18
    v_lshrrev_b32 v19, 5, v1
    v_xor_b32 v18, v18, v19
    v_lshl_add_u32 v20, v18, 4, v11
    v_xor_b32 v19, 2, v18
    v_lshl_add_u32 v21, v19, 4, v11
    v_xor_b32 v19, 4, v18
    v_lshl_add_u32 v22, v19, 4, v11
    v_xor_b32 v19, 6, v18
    v_lshl_add_u32 v23, v19, 4, v11
    v_lshrrev_b32 v18, 4, v1
    v_mul_u32_u24 v18, 16640, v18
    v_and_b32 v10, 15, v1
    v_lshl_add_u32 v10, v10, 4, v18
    s_add_u32 m0, s50, 4096
    s_add_u32 s52, s49, 128
    buffer_load_dwordx4 v14, s[8:11], s52 offen offset:0  lds
    s_add_u32 s52, s49, 8320
    buffer_load_dwordx4 v15, s[8:11], s52 offen offset:1024  lds
    s_add_u32 s52, s49, 16512
    buffer_load_dwordx4 v16, s[8:11], s52 offen offset:2048  lds
    s_add_u32 s52, s49, 24704
    buffer_load_dwordx4 v17, s[8:11], s52 offen offset:3072  lds
    s_cmp_lg_u32 s31, 0
    s_cbranch_scc1 T_H1
    s_add_u32 m0, s50, 0
    s_add_u32 s52, s49, 0
    buffer_load_dwordx4 v14, s[8:11], s52 offen offset:0  lds
    s_add_u32 s52, s49, 8192
    buffer_load_dwordx4 v15, s[8:11], s52 offen offset:1024  lds
    s_add_u32 s52, s49, 16384
    buffer_load_dwordx4 v16, s[8:11], s52 offen offset:2048  lds
    s_add_u32 s52, s49, 24576
    buffer_load_dwordx4 v17, s[8:11], s52 offen offset:3072  lds
    s_waitcnt vmcnt(16)
    ds_read_b64_tr_b16 v[96:97], v20 offset:16384
    ds_read_b64_tr_b16 v[98:99], v20 offset:16896
    ds_read_b64_tr_b16 v[100:101], v21 offset:16384
    ds_read_b64_tr_b16 v[102:103], v21 offset:16896
    ds_read_b64_tr_b16 v[104:105], v22 offset:16384
    ds_read_b64_tr_b16 v[106:107], v22 offset:16896
    ds_read_b64_tr_b16 v[108:109], v23 offset:16384
    ds_read_b64_tr_b16 v[110:111], v23 offset:16896
    s_add_u32 s52, s51, 1064960
    s_waitcnt lgkmcnt(6)
    buffer_store_dwordx4 v[96:99], v10, s[16:19], s52 offen sc1
    s_add_u32 s52, s51, 1131520
    s_waitcnt lgkmcnt(4)
    buffer_store_dwordx4 v[100:103], v10, s[16:19], s52 offen sc1
    s_add_u32 s52, s51, 1198080
    s_waitcnt lgkmcnt(2)
    buffer_store_dwordx4 v[104:107], v10, s[16:19], s52 offen sc1
    s_add_u32 s52, s51, 1264640
    s_waitcnt lgkmcnt(0)
    buffer_store_dwordx4 v[108:111], v10, s[16:19], s52 offen sc1
    s_waitcnt vmcnt(16)
    ds_read_b64_tr_b16 v[80:81], v20 offset:12288
    ds_read_b64_tr_b16 v[82:83], v20 offset:12800
    ds_read_b64_tr_b16 v[84:85], v21 offset:12288
    ds_read_b64_tr_b16 v[86:87], v21 offset:12800
    ds_read_b64_tr_b16 v[88:89], v22 offset:12288
    ds_read_b64_tr_b16 v[90:91], v22 offset:12800
    ds_read_b64_tr_b16 v[92:93], v23 offset:12288
    ds_read_b64_tr_b16 v[94:95], v23 offset:12800
    s_add_u32 s52, s51, 798720
    s_waitcnt lgkmcnt(6)
    buffer_store_dwordx4 v[80:83], v10, s[16:19], s52 offen sc1
    s_add_u32 s52, s51, 865280
    s_waitcnt lgkmcnt(4)
    buffer_store_dwordx4 v[84:87], v10, s[16:19], s52 offen sc1
    s_add_u32 s52, s51, 931840
    s_waitcnt lgkmcnt(2)
    buffer_store_dwordx4 v[88:91], v10, s[16:19], s52 offen sc1
    s_add_u32 s52, s51, 998400
    s_waitcnt lgkmcnt(0)
    buffer_store_dwordx4 v[92:95], v10, s[16:19], s52 offen sc1
    s_waitcnt vmcnt(16)
    ds_read_b64_tr_b16 v[64:65], v20 offset:8192
    ds_read_b64_tr_b16 v[66:67], v20 offset:8704
    ds_read_b64_tr_b16 v[68:69], v21 offset:8192
    ds_read_b64_tr_b16 v[70:71], v21 offset:8704
    ds_read_b64_tr_b16 v[72:73], v22 offset:8192
    ds_read_b64_tr_b16 v[74:75], v22 offset:8704
    ds_read_b64_tr_b16 v[76:77], v23 offset:8192
    ds_read_b64_tr_b16 v[78:79], v23 offset:8704
    s_add_u32 s52, s51, 532480
    s_waitcnt lgkmcnt(6)
    buffer_store_dwordx4 v[64:67], v10, s[16:19], s52 offen sc1
    s_add_u32 s52, s51, 599040
    s_waitcnt lgkmcnt(4)
    buffer_store_dwordx4 v[68:71], v10, s[16:19], s52 offen sc1
    s_add_u32 s52, s51, 665600
    s_waitcnt lgkmcnt(2)
    buffer_store_dwordx4 v[72:75], v10, s[16:19], s52 offen sc1
    s_add_u32 s52, s51, 732160
    s_waitcnt lgkmcnt(0)
    buffer_store_dwordx4 v[76:79], v10, s[16:19], s52 offen sc1
    s_waitcnt vmcnt(16)
    ds_read_b64_tr_b16 v[48:49], v20 offset:4096
    ds_read_b64_tr_b16 v[50:51], v20 offset:4608
    ds_read_b64_tr_b16 v[52:53], v21 offset:4096
    ds_read_b64_tr_b16 v[54:55], v21 offset:4608
    ds_read_b64_tr_b16 v[56:57], v22 offset:4096
    ds_read_b64_tr_b16 v[58:59], v22 offset:4608
    ds_read_b64_tr_b16 v[60:61], v23 offset:4096
    ds_read_b64_tr_b16 v[62:63], v23 offset:4608
    s_add_u32 s52, s51, 266240
    s_waitcnt lgkmcnt(6)
    buffer_store_dwordx4 v[48:51], v10, s[16:19], s52 offen sc1
    s_add_u32 s52, s51, 332800
    s_waitcnt lgkmcnt(4)
    buffer_store_dwordx4 v[52:55], v10, s[16:19], s52 offen sc1
    s_add_u32 s52, s51, 399360
    s_waitcnt lgkmcnt(2)
    buffer_store_dwordx4 v[56:59], v10, s[16:19], s52 offen sc1
    s_add_u32 s52, s51, 465920
    s_waitcnt lgkmcnt(0)
    buffer_store_dwordx4 v[60:63], v10, s[16:19], s52 offen sc1
    s_waitcnt vmcnt(16)
    ds_read_b64_tr_b16 v[32:33], v20 offset:0
    ds_read_b64_tr_b16 v[34:35], v20 offset:512
    ds_read_b64_tr_b16 v[36:37], v21 offset:0
    ds_read_b64_tr_b16 v[38:39], v21 offset:512
    ds_read_b64_tr_b16 v[40:41], v22 offset:0
    ds_read_b64_tr_b16 v[42:43], v22 offset:512
    ds_read_b64_tr_b16 v[44:45], v23 offset:0
    ds_read_b64_tr_b16 v[46:47], v23 offset:512
    s_add_u32 s52, s51, 0
    s_waitcnt lgkmcnt(6)
    buffer_store_dwordx4 v[32:35], v10, s[16:19], s52 offen sc1
    s_add_u32 s52, s51, 66560
    s_waitcnt lgkmcnt(4)
    buffer_store_dwordx4 v[36:39], v10, s[16:19], s52 offen sc1
    s_add_u32 s52, s51, 133120
    s_waitcnt lgkmcnt(2)
    buffer_store_dwordx4 v[40:43], v10, s[16:19], s52 offen sc1
    s_add_u32 s52, s51, 199680
    s_waitcnt lgkmcnt(0)
    buffer_store_dwordx4 v[44:47], v10, s[16:19], s52 offen sc1
    s_branch T_J
T_H1:
    s_waitcnt vmcnt(12)
    ds_read_b64_tr_b16 v[96:97], v20 offset:16384
    ds_read_b64_tr_b16 v[98:99], v20 offset:16896
    ds_read_b64_tr_b16 v[100:101], v21 offset:16384
    ds_read_b64_tr_b16 v[102:103], v21 offset:16896
    ds_read_b64_tr_b16 v[104:105], v22 offset:16384
    ds_read_b64_tr_b16 v[106:107], v22 offset:16896
    ds_read_b64_tr_b16 v[108:109], v23 offset:16384
    ds_read_b64_tr_b16 v[110:111], v23 offset:16896
    s_add_u32 s52, s51, 1064960
    s_waitcnt lgkmcnt(6)
    buffer_store_dwordx4 v[96:99], v10, s[16:19], s52 offen sc1
    s_add_u32 s52, s51, 1131520
    s_waitcnt lgkmcnt(4)
    buffer_store_dwordx4 v[100:103], v10, s[16:19], s52 offen sc1
    s_add_u32 s52, s51, 1198080
    s_waitcnt lgkmcnt(2)
    buffer_store_dwordx4 v[104:107], v10, s[16:19], s52 offen sc1
    s_add_u32 s52, s51, 1264640
    s_waitcnt lgkmcnt(0)
    buffer_store_dwordx4 v[108:111], v10, s[16:19], s52 offen sc1
    s_waitcnt vmcnt(12)
    ds_read_b64_tr_b16 v[80:81], v20 offset:12288
    ds_read_b64_tr_b16 v[82:83], v20 offset:12800
    ds_read_b64_tr_b16 v[84:85], v21 offset:12288
    ds_read_b64_tr_b16 v[86:87], v21 offset:12800
    ds_read_b64_tr_b16 v[88:89], v22 offset:12288
    ds_read_b64_tr_b16 v[90:91], v22 offset:12800
    ds_read_b64_tr_b16 v[92:93], v23 offset:12288
    ds_read_b64_tr_b16 v[94:95], v23 offset:12800
    s_add_u32 s52, s51, 798720
    s_waitcnt lgkmcnt(6)
    buffer_store_dwordx4 v[80:83], v10, s[16:19], s52 offen sc1
    s_add_u32 s52, s51, 865280
    s_waitcnt lgkmcnt(4)
    buffer_store_dwordx4 v[84:87], v10, s[16:19], s52 offen sc1
    s_add_u32 s52, s51, 931840
    s_waitcnt lgkmcnt(2)
    buffer_store_dwordx4 v[88:91], v10, s[16:19], s52 offen sc1
    s_add_u32 s52, s51, 998400
    s_waitcnt lgkmcnt(0)
    buffer_store_dwordx4 v[92:95], v10, s[16:19], s52 offen sc1
    s_waitcnt vmcnt(12)
    ds_read_b64_tr_b16 v[64:65], v20 offset:8192
    ds_read_b64_tr_b16 v[66:67], v20 offset:8704
    ds_read_b64_tr_b16 v[68:69], v21 offset:8192
    ds_read_b64_tr_b16 v[70:71], v21 offset:8704
    ds_read_b64_tr_b16 v[72:73], v22 offset:8192
    ds_read_b64_tr_b16 v[74:75], v22 offset:8704
    ds_read_b64_tr_b16 v[76:77], v23 offset:8192
    ds_read_b64_tr_b16 v[78:79], v23 offset:8704
    s_add_u32 s52, s51, 532480
    s_waitcnt lgkmcnt(6)
    buffer_store_dwordx4 v[64:67], v10, s[16:19], s52 offen sc1
    s_add_u32 s52, s51, 599040
    s_waitcnt lgkmcnt(4)
    buffer_store_dwordx4 v[68:71], v10, s[16:19], s52 offen sc1
    s_add_u32 s52, s51, 665600
    s_waitcnt lgkmcnt(2)
    buffer_store_dwordx4 v[72:75], v10, s[16:19], s52 offen sc1
    s_add_u32 s52, s51, 732160
    s_waitcnt lgkmcnt(0)
    buffer_store_dwordx4 v[76:79], v10, s[16:19], s52 offen sc1
    s_waitcnt vmcnt(12)
    ds_read_b64_tr_b16 v[48:49], v20 offset:4096
    ds_read_b64_tr_b16 v[50:51], v20 offset:4608
    ds_read_b64_tr_b16 v[52:53], v21 offset:4096
    ds_read_b64_tr_b16 v[54:55], v21 offset:4608
    ds_read_b64_tr_b16 v[56:57], v22 offset:4096
    ds_read_b64_tr_b16 v[58:59], v22 offset:4608
    ds_read_b64_tr_b16 v[60:61], v23 offset:4096
    ds_read_b64_tr_b16 v[62:63], v23 offset:4608
    s_add_u32 s52, s51, 266240
    s_waitcnt lgkmcnt(6)
    buffer_store_dwordx4 v[48:51], v10, s[16:19], s52 offen sc1
    s_add_u32 s52, s51, 332800
    s_waitcnt lgkmcnt(4)
    buffer_store_dwordx4 v[52:55], v10, s[16:19], s52 offen sc1
    s_add_u32 s52, s51, 399360
    s_waitcnt lgkmcnt(2)
    buffer_store_dwordx4 v[56:59], v10, s[16:19], s52 offen sc1
    s_add_u32 s52, s51, 465920
    s_waitcnt lgkmcnt(0)
    buffer_store_dwordx4 v[60:63], v10, s[16:19], s52 offen sc1
T_J:
    s_lshl_b32 s28, s20, 2
    s_add_u32 s28, s28, 163664
    v_mov_b32 v26, s28
    v_mov_b32 v27, 1
    s_mov_b64 exec, 1
    ds_write_b32 v26, v27 offset:0
    s_mov_b64 exec, -1
    s_lshl_b32 s28, s31, 6
    s_add_u32 s28, s28, s48
    s_lshl_b32 s28, s28, 2
    s_add_u32 s28, s28, 15906816
    v_lshlrev_b32 v28, 9, v1
    s_load_dword s60, s[6:7], 0
    s_waitcnt lgkmcnt(0)
    s_cmp_lg_u32 s60, 0
    s_cbranch_scc1 ND_T
    v_mov_b32 v24, 0
    global_load_dword v25, v24, s[6:7] sc1
    s_mov_b32 s65, 20000
NL_T:
    s_waitcnt vmcnt(0)
    v_readfirstlane_b32 s60, v25
    s_nop 0
    s_cmp_lg_u32 s60, 0
    s_cbranch_scc1 ND_T
    s_sleep 2
    global_load_dword v25, v24, s[6:7] sc1
    s_sub_u32 s65, s65, 1
    s_cmp_lg_u32 s65, 0
    s_cbranch_scc1 NL_T
    s_waitcnt vmcnt(0)
ND_T:
    s_waitcnt vmcnt(0)
    v_mov_b32 v29, s60
    s_mov_b64 exec, 0xffff
    buffer_atomic_swap v29, v28, s[16:19], s28 offen sc1
    s_mov_b64 exec, -1
    s_cmp_ge_u32 s20, 10
    s_cbranch_scc1 F_ATT
    s_mul_i32 s31, s21, 72
    s_lshl_b32 s26, s22, 2
    s_add_u32 s31, s31, s26
    s_sub_u32 s31, s31, 56
    s_and_b32 s26, s20, 1
    s_lshl_b32 s27, s26, 1
    s_add_u32 s31, s31, s27
    s_cmp_eq_u32 s26, 0
    s_mov_b32 s53, 46080
    s_cmov_b32 s53, 36864
    v_and_b32 v7, 3, v1
    v_lshlrev_b32 v7, 2, v7
    v_add_u32 v7, 163696, v7
    s_lshr_b32 s26, s31, 2
    s_mul_i32 s26, s26, 16640
    s_and_b32 s27, s31, 2
    s_lshl_b32 s27, s27, 4
    s_add_u32 s26, s26, s27
    s_add_u32 s26, s26, 6553600
    v_lshrrev_b32 v6, 4, v1
    v_xor_b32 v6, v6, v1
    v_and_b32 v5, 1, v6
    v_bfe_u32 v6, v6, 1, 1
    v_lshl_add_u32 v6, v6, 2, v5
    v_lshrrev_b32 v5, 2, v1
    v_lshl_add_u32 v6, v5, 3, v6
    v_lshlrev_b32 v6, 4, v6
    s_cmp_ge_u32 s31, 320
    s_mov_b32 s68, 15906816
    s_cmov_b32 s68, 15907072
    s_and_b32 s69, s22, 15
    s_lshl_b32 s69, s69, 9
    s_add_u32 s68, s68, s69
    v_lshl_add_u32 v162, v1, 2, s68
    s_mov_b32 s65, 160000
LL_HD:
    ds_read_b32 v8, v7 offset:0
    s_waitcnt lgkmcnt(0)
    v_cmp_gt_u32 s[66:67], 1, v8
    s_nop 0
    s_cmp_eq_u64 s[66:67], 0
    s_cbranch_scc1 LD_HD
    s_sleep 2
    s_sub_u32 s65, s65, 1
    s_cmp_lg_u32 s65, 0
    s_cbranch_scc1 LL_HD
LD_HD:
    v_lshlrev_b32 v7, 4, v1
    v_add_u32 v7, s53, v7
    v_mov_b32 v8, 0
    v_mov_b32 v9, 0
    v_mov_b32 v10, 0
    v_mov_b32 v11, 0
    ds_write_b128 v7, v[8:11]
    s_mov_b32 s65, 20000
PL_HU:
    v_mov_b32 v163, 0
    buffer_atomic_or v163, v162, s[16:19], 0 offen sc0 sc1
    s_waitcnt vmcnt(0)
    v_cmp_ne_u32 s[66:67], s60, v163
    s_nop 0
    s_cmp_eq_u64 s[66:67], 0
    s_cbranch_scc1 PD_HU
    s_sleep 2
    s_sub_u32 s65, s65, 1
    s_cmp_lg_u32 s65, 0
    s_cbranch_scc1 PL_HU
PD_HU:
    s_add_u32 m0, s53, 1024
    s_add_u32 s27, s26, 0
    buffer_load_dwordx4 v6, s[16:19], s27 offen offset:0 sc1 lds
    s_add_u32 s27, s26, 1024
    buffer_load_dwordx4 v6, s[16:19], s27 offen offset:1024 sc1 lds
    s_add_u32 s27, s26, 2048
    buffer_load_dwordx4 v6, s[16:19], s27 offen offset:2048 sc1 lds
    s_add_u32 s27, s26, 3072
    buffer_load_dwordx4 v6, s[16:19], s27 offen offset:3072 sc1 lds
    s_add_u32 m0, s53, 5120
    s_add_u32 s27, s26, 8192
    buffer_load_dwordx4 v6, s[16:19], s27 offen offset:0 sc1 lds
    s_add_u32 s27, s26, 9216
    buffer_load_dwordx4 v6, s[16:19], s27 offen offset:1024 sc1 lds
    s_add_u32 s27, s26, 10240
    buffer_load_dwordx4 v6, s[16:19], s27 offen offset:2048 sc1 lds
    s_add_u32 s27, s26, 11264
    buffer_load_dwordx4 v6, s[16:19], s27 offen offset:3072 sc1 lds
    s_waitcnt vmcnt(0) lgkmcnt(0)
    v_mov_b32 v27, 2
    s_mov_b64 exec, 1
    ds_write_b32 v26, v27 offset:0
    s_mov_b64 exec, -1
    s_branch F_ATT
F_C:
    s_mul_i32 s28, s22, 37
    s_lshr_b32 s28, s28, 8
    s_mul_i32 s29, s28, 7
    s_sub_u32 s29, s22, s29
    s_lshr_b32 s23, s21, 1
    s_lshl_b32 s23, s23, 2
    s_add_u32 s23, s23, s28
    s_and_b32 s24, s21, 1
    s_mul_i32 s24, s24, 7
    s_add_u32 s24, s24, s29
    s_add_u32 s25, s28, s29
    s_mul_i32 s28, s25, 43
    s_lshr_b32 s28, s28, 7
    s_mul_i32 s28, s28, 3
    s_sub_u32 s25, s25, s28
    s_mul_i32 s25, s25, 3
    s_setprio 1
    v_mov_b32 v26, 163584
    v_mov_b32 v27, 1
    s_bfe_u32 s26, s20, 0x10001
    s_and_b32 s27, s20, 1
    v_and_b32 v14, 15, v1
    v_lshrrev_b32 v15, 4, v1
    s_lshl_b32 s28, s23, 2
    s_lshl_b32 s29, s26, 1
    s_add_u32 s28, s28, s29
    v_bfe_u32 v16, v1, 2, 2
    v_lshl_add_u32 v17, v15, 3, v16
    v_lshlrev_b32 v17, 8, v17
    v_and_b32 v18, 3, v1
    v_lshl_add_u32 v17, v18, 3, v17
    v_add_u32 v17, 32768, v17
    v_and_b32 v18, 1, v15
    v_lshl_or_b32 v16, v16, 1, v18
    s_lshl_b32 s29, s27, 2
    v_xor_b32 v16, s29, v16
    v_lshl_add_u32 v6, v16, 5, v17
    v_xor_b32 v18, 1, v16
    v_lshl_add_u32 v7, v18, 5, v17
    v_xor_b32 v18, 2, v16
    v_lshl_add_u32 v8, v18, 5, v17
    v_xor_b32 v18, 3, v16
    v_lshl_add_u32 v9, v18, 5, v17
    v_and_b32 v19, 12, v14
    v_add_u32 v19, v19, v14
    s_cmp_ge_u32 s24, 9
    s_cselect_b64 s[30:31], -1, 0
    s_cselect_b32 s56, 4, 1
    s_lshl_b32 s29, s26, 13
    s_add_u32 s29, s29, 32768
    v_lshlrev_b32 v16, 1, v14
    v_cndmask_b32 v16, v16, v19, s[30:31]
    v_add_u32 v17, s56, v16
    v_lshrrev_b32 v18, 1, v16
    v_and_b32 v20, 1, v16
    v_lshl_add_u32 v20, v20, 3, v15
    v_and_b32 v21, 5, v18
    v_bfe_u32 v22, v18, 1, 1
    v_lshl_or_b32 v21, v22, 3, v21
    v_bfe_u32 v22, v18, 3, 1
    v_lshl_or_b32 v21, v22, 1, v21
    v_xor_b32 v20, v20, v21
    v_lshlrev_b32 v18, 8, v18
    v_add_u32 v18, s29, v18
    v_lshl_add_u32 v2, v20, 4, v18
    v_xor_b32 v20, 4, v20
    v_lshl_add_u32 v4, v20, 4, v18
    v_lshrrev_b32 v18, 1, v17
    v_and_b32 v20, 1, v17
    v_lshl_add_u32 v20, v20, 3, v15
    v_and_b32 v21, 5, v18
    v_bfe_u32 v22, v18, 1, 1
    v_lshl_or_b32 v21, v22, 3, v21
    v_bfe_u32 v22, v18, 3, 1
    v_lshl_or_b32 v21, v22, 1, v21
    v_xor_b32 v20, v20, v21
    v_lshlrev_b32 v18, 8, v18
    v_add_u32 v18, s29, v18
    v_lshl_add_u32 v3, v20, 4, v18
    v_xor_b32 v20, 4, v20
    v_lshl_add_u32 v5, v20, 4, v18
    s_mul_i32 s30, s24, 466048
    s_lshr_b32 s30, s30, 16
    s_sub_u32 s30, s30, 1
    v_add_u32 v20, s30, v1
    v_mul_u32_u24 v21, 18, v20
    v_cmp_gt_u32 s[52:53], 64, v20
    v_and_b32 v22, 1, v20
    v_lshlrev_b32 v22, 1, v22
    v_cndmask_b32 v22, 0, v22, s[52:53]
    v_sub_u32 v21, v21, v22
    v_cndmask_b32 v22, 17, 19, s[52:53]
    v_add_u32 v22, v21, v22
    v_lshrrev_b32 v21, 7, v21
    v_lshrrev_b32 v22, 7, v22
    v_cmp_eq_u32 s[52:53], s24, v21
    v_cmp_eq_u32 s[54:55], s24, v22
    v_cmp_gt_u32 vcc, 96, v20
    v_and_b32 v21, 31, v20
    v_lshrrev_b32 v22, 5, v20
    v_mul_u32_u24 v21, 512, v21
    v_lshl_add_u32 v21, v22, 7, v21
    v_cndmask_b32 v22, 64, 0, s[52:53]
    s_lshl_b32 s30, s23, 2
    s_add_u32 s30, s30, 15781888
    v_add3_u32 v12, v21, v22, s30
    s_or_b64 s[52:53], s[52:53], s[54:55]
    s_and_b64 s[52:53], s[52:53], vcc
    s_lshl_b32 s30, s23, 7
    s_add_u32 s30, s30, 15798272
    v_writelane_b32 v12, s30, 63
    s_cmp_eq_u32 s24, 13
    s_cselect_b32 s53, 0x80000000, 0
    v_mov_b32 v96, 0
    v_mov_b32 v97, 0
    v_mov_b32 v98, 0
    v_mov_b32 v99, 0
    v_mov_b32 v100, 0
    v_mov_b32 v101, 0
    v_mov_b32 v102, 0
    v_mov_b32 v103, 0
    v_mov_b32 v104, 0
    v_mov_b32 v105, 0
    v_mov_b32 v106, 0
    v_mov_b32 v107, 0
    v_mov_b32 v108, 0
    v_mov_b32 v109, 0
    v_mov_b32 v110, 0
    v_mov_b32 v111, 0
    v_mov_b32 v112, 0
    v_mov_b32 v113, 0
    v_mov_b32 v114, 0
    v_mov_b32 v115, 0
    v_mov_b32 v116, 0
    v_mov_b32 v117, 0
    v_mov_b32 v118, 0
    v_mov_b32 v119, 0
    v_mov_b32 v120, 0
    v_mov_b32 v121, 0
    v_mov_b32 v122, 0
    v_mov_b32 v123, 0
    v_mov_b32 v124, 0
    v_mov_b32 v125, 0
    v_mov_b32 v126, 0
    v_mov_b32 v127, 0
    v_mov_b32 v128, 0
    v_mov_b32 v129, 0
    v_mov_b32 v130, 0
    v_mov_b32 v131, 0
    v_mov_b32 v132, 0
    v_mov_b32 v133, 0
    v_mov_b32 v134, 0
    v_mov_b32 v135, 0
    v_mov_b32 v136, 0
    v_mov_b32 v137, 0
    v_mov_b32 v138, 0
    v_mov_b32 v139, 0
    v_mov_b32 v140, 0
    v_mov_b32 v141, 0
    v_mov_b32 v142, 0
    v_mov_b32 v143, 0
    v_mov_b32 v144, 0
    v_mov_b32 v145, 0
    v_mov_b32 v146, 0
    v_mov_b32 v147, 0
    v_mov_b32 v148, 0
    v_mov_b32 v149, 0
    v_mov_b32 v150, 0
    v_mov_b32 v151, 0
    v_mov_b32 v152, 0
    v_mov_b32 v153, 0
    v_mov_b32 v154, 0
    v_mov_b32 v155, 0
    v_mov_b32 v156, 0
    v_mov_b32 v157, 0
    v_mov_b32 v158, 0
    v_mov_b32 v159, 0
    s_waitcnt lgkmcnt(0)
    s_mov_b32 s40, 1
    s_mov_b32 s41, 1
    s_mov_b32 s43, 32768
    s_mov_b32 s44, -65536
    s_cmp_ge_u32 s24, 9
    s_cbranch_scc1 C_V
    s_lshl_b32 s29, s24, 5
    s_lshl_b32 s30, s27, 4
    s_add_u32 s29, s29, s30
    s_cmp_ge_u32 s29, 144
    s_cselect_b32 s30, 144, 0
    s_cselect_b32 s34, 1.0, 0x3eae1a93
    s_mov_b32 s36, 65536
    s_cmov_b32 s36, 139264
    s_mov_b32 s37, 8192
    s_cmov_b32 s37, 17408
    s_mov_b32 s38, 0
    s_cmov_b32 s38, 2097152
    s_mov_b32 s39, 13668352
    s_cmov_b32 s39, 14716928
    s_mov_b32 s35, s34
    s_sub_u32 s29, s29, s30
    s_lshr_b32 s30, s28, 3
    s_mul_i32 s30, s30, s37
    s_add_u32 s38, s38, s30
    s_and_b32 s30, s28, 7
    s_lshl_b32 s30, s30, 10
    s_add_u32 s38, s38, s30
    s_lshl_b32 s30, s28, 10
    s_add_u32 s39, s39, s30
    v_and_b32 v43, 15, v1
    v_add_u32 v43, s29, v43
    v_mul_u32_u24 v44, 57, v43
    v_lshrrev_b32 v44, 9, v44
    v_mul_u32_u24 v45, 9, v44
    v_sub_u32 v45, v43, v45
    v_add_u32 v47, 3, v45
    v_lshrrev_b32 v47, 3, v47
    v_lshl_add_u32 v46, v44, 1, v47
    v_mul_u32_u24 v47, 5, v47
    v_sub_u32 v47, v45, v47
    v_mul_lo_u32 v46, v46, s36
    v_add_u32 v46, s38, v46
    v_lshrrev_b32 v48, 1, v47
    v_lshl_add_u32 v46, v48, 8, v46
    v_and_b32 v48, 1, v47
    v_cmp_eq_u32 s[30:31], 4, v45
    v_lshl_add_u32 v46, v48, 9, v46
    v_lshlrev_b32 v49, 16, v44
    v_add_u32 v49, s39, v49
    v_cndmask_b32 v46, v46, v49, s[30:31]
    v_lshlrev_b32 v47, 2, v15
    v_lshlrev_b32 v48, 4, v14
    ds_bpermute_b32 v16, v47, v46 offset:0
    ds_bpermute_b32 v17, v47, v46 offset:16
    ds_bpermute_b32 v18, v47, v46 offset:32
    ds_bpermute_b32 v19, v47, v46 offset:48
    s_waitcnt lgkmcnt(0)
    v_add_u32 v16, v16, v48
    v_add_u32 v17, v17, v48
    v_add_u32 v18, v18, v48
    v_add_u32 v19, v19, v48
    s_barrier
    ds_read_b64_tr_b16 v[48:49], v6 offset:16384
    ds_read_b64_tr_b16 v[50:51], v6 offset:17408
    ds_read_b128 v[32:35], v2 offset:0
    ds_read_b128 v[36:39], v3 offset:0
    ds_read_b128 v[40:43], v2 offset:4096
    ds_read_b128 v[44:47], v3 offset:4096
    ds_read_b64_tr_b16 v[52:53], v7 offset:16384
    ds_read_b64_tr_b16 v[54:55], v7 offset:17408
    ds_read_b64_tr_b16 v[56:57], v8 offset:16384
    ds_read_b64_tr_b16 v[58:59], v8 offset:17408
    ds_read_b64_tr_b16 v[60:61], v9 offset:16384
    ds_read_b64_tr_b16 v[62:63], v9 offset:17408
.p2align 3
CT_Q:
    s_waitcnt lgkmcnt(6)
    v_mfma_f32_16x16x32_bf16 v[96:99], v[48:51], v[32:35], v[96:99]
    ds_read_b64_tr_b16 v[80:81], v6 offset:24576
    v_mfma_f32_16x16x32_bf16 v[100:103], v[48:51], v[36:39], v[100:103]
    ds_read_b64_tr_b16 v[82:83], v6 offset:25600
    v_mfma_f32_16x16x32_bf16 v[104:107], v[48:51], v[40:43], v[104:107]
    ds_read_b128 v[64:67], v4 offset:0
    v_mfma_f32_16x16x32_bf16 v[108:111], v[48:51], v[44:47], v[108:111]
    ds_read_b128 v[68:71], v5 offset:0
    s_waitcnt lgkmcnt(8)
    v_mfma_f32_16x16x32_bf16 v[124:127], v[52:55], v[44:47], v[124:127]
    ds_read_b128 v[72:75], v4 offset:4096
    v_mfma_f32_16x16x32_bf16 v[120:123], v[52:55], v[40:43], v[120:123]
    ds_read_b128 v[76:79], v5 offset:4096
    v_mfma_f32_16x16x32_bf16 v[116:119], v[52:55], v[36:39], v[116:119]
    ds_read_b64_tr_b16 v[84:85], v7 offset:24576
    v_mfma_f32_16x16x32_bf16 v[112:115], v[52:55], v[32:35], v[112:115]
    ds_read_b64_tr_b16 v[86:87], v7 offset:25600
    s_waitcnt lgkmcnt(10)
    v_mfma_f32_16x16x32_bf16 v[128:131], v[56:59], v[32:35], v[128:131]
    ds_read_b64_tr_b16 v[88:89], v8 offset:24576
    v_mfma_f32_16x16x32_bf16 v[132:135], v[56:59], v[36:39], v[132:135]
    ds_read_b64_tr_b16 v[90:91], v8 offset:25600
    v_mfma_f32_16x16x32_bf16 v[136:139], v[56:59], v[40:43], v[136:139]
    ds_read_b64_tr_b16 v[92:93], v9 offset:24576
    v_mfma_f32_16x16x32_bf16 v[140:143], v[56:59], v[44:47], v[140:143]
    ds_read_b64_tr_b16 v[94:95], v9 offset:25600
    s_waitcnt lgkmcnt(12)
    v_mfma_f32_16x16x32_bf16 v[156:159], v[60:63], v[44:47], v[156:159]
    s_add_u32 s41, s41, 1
    s_cmp_eq_u32 s41, 3
    v_mfma_f32_16x16x32_bf16 v[152:155], v[60:63], v[40:43], v[152:155]
    s_cselect_b32 s41, 0, s41
    s_cselect_b32 s42, s44, s43
    v_mfma_f32_16x16x32_bf16 v[148:151], v[60:63], v[36:39], v[148:151]
    v_add_u32 v2, s42, v2
    v_add_u32 v3, s42, v3
    v_mfma_f32_16x16x32_bf16 v[144:147], v[60:63], v[32:35], v[144:147]
    s_add_u32 s40, s40, 1
    s_cmp_eq_u32 s40, 10
    s_waitcnt lgkmcnt(0)
    s_cbranch_scc1 CE_Q
    v_mfma_f32_16x16x32_bf16 v[96:99], v[80:83], v[64:67], v[96:99]
    v_add_u32 v6, s42, v6
    v_add_u32 v7, s42, v7
    v_mfma_f32_16x16x32_bf16 v[100:103], v[80:83], v[68:71], v[100:103]
    s_barrier
    v_mfma_f32_16x16x32_bf16 v[104:107], v[80:83], v[72:75], v[104:107]
    ds_read_b64_tr_b16 v[48:49], v6 offset:16384
    v_mfma_f32_16x16x32_bf16 v[108:111], v[80:83], v[76:79], v[108:111]
    ds_read_b64_tr_b16 v[50:51], v6 offset:17408
    v_add_u32 v8, s42, v8
    v_mfma_f32_16x16x32_bf16 v[124:127], v[84:87], v[76:79], v[124:127]
    ds_read_b128 v[32:35], v2 offset:0
    v_mfma_f32_16x16x32_bf16 v[120:123], v[84:87], v[72:75], v[120:123]
    ds_read_b128 v[36:39], v3 offset:0
    v_add_u32 v9, s42, v9
    v_mfma_f32_16x16x32_bf16 v[116:119], v[84:87], v[68:71], v[116:119]
    ds_read_b128 v[40:43], v2 offset:4096
    v_mfma_f32_16x16x32_bf16 v[112:115], v[84:87], v[64:67], v[112:115]
    ds_read_b128 v[44:47], v3 offset:4096
    v_mfma_f32_16x16x32_bf16 v[128:131], v[88:91], v[64:67], v[128:131]
    ds_read_b64_tr_b16 v[52:53], v7 offset:16384
    v_mfma_f32_16x16x32_bf16 v[132:135], v[88:91], v[68:71], v[132:135]
    ds_read_b64_tr_b16 v[54:55], v7 offset:17408
    v_mfma_f32_16x16x32_bf16 v[136:139], v[88:91], v[72:75], v[136:139]
    ds_read_b64_tr_b16 v[56:57], v8 offset:16384
    v_mfma_f32_16x16x32_bf16 v[140:143], v[88:91], v[76:79], v[140:143]
    ds_read_b64_tr_b16 v[58:59], v8 offset:17408
    v_mfma_f32_16x16x32_bf16 v[156:159], v[92:95], v[76:79], v[156:159]
    ds_read_b64_tr_b16 v[60:61], v9 offset:16384
    v_mfma_f32_16x16x32_bf16 v[152:155], v[92:95], v[72:75], v[152:155]
    ds_read_b64_tr_b16 v[62:63], v9 offset:17408
    v_mfma_f32_16x16x32_bf16 v[148:151], v[92:95], v[68:71], v[148:151]
    v_add_u32 v4, s42, v4
    v_add_u32 v5, s42, v5
    v_mfma_f32_16x16x32_bf16 v[144:147], v[92:95], v[64:67], v[144:147]
    s_branch CT_Q
CE_Q:
    s_setprio 3
    s_cmp_eq_u32 s34, 1.0
    s_cbranch_scc1 C_KST
    v_mfma_f32_16x16x32_bf16 v[96:99], v[80:83], v[64:67], v[96:99]
    v_mfma_f32_16x16x32_bf16 v[100:103], v[80:83], v[68:71], v[100:103]
    v_mfma_f32_16x16x32_bf16 v[104:107], v[80:83], v[72:75], v[104:107]
    v_mfma_f32_16x16x32_bf16 v[108:111], v[80:83], v[76:79], v[108:111]
    v_mfma_f32_16x16x32_bf16 v[124:127], v[84:87], v[76:79], v[124:127]
    v_mfma_f32_16x16x32_bf16 v[120:123], v[84:87], v[72:75], v[120:123]
    v_mfma_f32_16x16x32_bf16 v[116:119], v[84:87], v[68:71], v[116:119]
    v_mfma_f32_16x16x32_bf16 v[112:115], v[84:87], v[64:67], v[112:115]
    v_mfma_f32_16x16x32_bf16 v[128:131], v[88:91], v[64:67], v[128:131]
    v_mul_f32 v96, s34, v96
    v_mul_f32 v97, s34, v97
    v_mfma_f32_16x16x32_bf16 v[132:135], v[88:91], v[68:71], v[132:135]
    v_mul_f32 v98, s34, v98
    v_mul_f32 v99, s34, v99
    v_mfma_f32_16x16x32_bf16 v[136:139], v[88:91], v[72:75], v[136:139]
    v_mul_f32 v100, s34, v100
    v_mul_f32 v101, s34, v101
    v_mfma_f32_16x16x32_bf16 v[140:143], v[88:91], v[76:79], v[140:143]
    v_mul_f32 v102, s34, v102
    v_mul_f32 v103, s34, v103
    v_mfma_f32_16x16x32_bf16 v[156:159], v[92:95], v[76:79], v[156:159]
    v_cvt_pk_bf16_f32 v32, v96, v97
    v_cvt_pk_bf16_f32 v33, v98, v99
    v_mfma_f32_16x16x32_bf16 v[152:155], v[92:95], v[72:75], v[152:155]
    v_cvt_pk_bf16_f32 v34, v100, v101
    v_cvt_pk_bf16_f32 v35, v102, v103
    v_mfma_f32_16x16x32_bf16 v[148:151], v[92:95], v[68:71], v[148:151]
    buffer_store_dwordx4 v[32:35], v16, s[16:19], 0 offen offset:0 sc1
    v_mul_f32 v104, s34, v104
    v_mfma_f32_16x16x32_bf16 v[144:147], v[92:95], v[64:67], v[144:147]
    v_mul_f32 v105, s34, v105
    v_mul_f32 v106, s34, v106
    v_mul_f32 v107, s34, v107
    v_mul_f32 v108, s34, v108
    v_mul_f32 v109, s34, v109
    v_mul_f32 v110, s34, v110
    v_mul_f32 v111, s34, v111
    v_cvt_pk_bf16_f32 v36, v104, v105
    v_cvt_pk_bf16_f32 v37, v106, v107
    v_cvt_pk_bf16_f32 v38, v108, v109
    v_cvt_pk_bf16_f32 v39, v110, v111
    buffer_store_dwordx4 v[36:39], v16, s[16:19], 0 offen offset:1024 sc1
    v_mul_f32 v112, s34, v112
    v_mul_f32 v113, s34, v113
    v_mul_f32 v114, s34, v114
    v_mul_f32 v115, s34, v115
    v_mul_f32 v116, s34, v116
    v_mul_f32 v117, s34, v117
    v_mul_f32 v118, s34, v118
    v_mul_f32 v119, s34, v119
    v_cvt_pk_bf16_f32 v40, v112, v113
    v_cvt_pk_bf16_f32 v41, v114, v115
    v_cvt_pk_bf16_f32 v42, v116, v117
    v_cvt_pk_bf16_f32 v43, v118, v119
    buffer_store_dwordx4 v[40:43], v17, s[16:19], 0 offen offset:0 sc1
    v_mul_f32 v120, s34, v120
    v_mul_f32 v121, s34, v121
    v_mul_f32 v122, s34, v122
    v_mul_f32 v123, s34, v123
    v_mul_f32 v124, s34, v124
    v_mul_f32 v125, s34, v125
    v_mul_f32 v126, s34, v126
    v_mul_f32 v127, s34, v127
    v_cvt_pk_bf16_f32 v44, v120, v121
    v_cvt_pk_bf16_f32 v45, v122, v123
    v_cvt_pk_bf16_f32 v46, v124, v125
    v_cvt_pk_bf16_f32 v47, v126, v127
    buffer_store_dwordx4 v[44:47], v17, s[16:19], 0 offen offset:1024 sc1
    v_mul_f32 v128, s34, v128
    v_mul_f32 v129, s34, v129
    v_mul_f32 v130, s34, v130
    v_mul_f32 v131, s34, v131
    v_mul_f32 v132, s34, v132
    v_mul_f32 v133, s34, v133
    v_mul_f32 v134, s34, v134
    v_mul_f32 v135, s34, v135
    v_cvt_pk_bf16_f32 v48, v128, v129
    v_cvt_pk_bf16_f32 v49, v130, v131
    v_cvt_pk_bf16_f32 v50, v132, v133
    v_cvt_pk_bf16_f32 v51, v134, v135
    buffer_store_dwordx4 v[48:51], v18, s[16:19], 0 offen offset:0 sc1
    v_mul_f32 v136, s34, v136
    v_mul_f32 v137, s34, v137
    v_mul_f32 v138, s34, v138
    v_mul_f32 v139, s34, v139
    v_mul_f32 v140, s34, v140
    v_mul_f32 v141, s34, v141
    v_mul_f32 v142, s34, v142
    v_mul_f32 v143, s34, v143
    v_cvt_pk_bf16_f32 v52, v136, v137
    v_cvt_pk_bf16_f32 v53, v138, v139
    v_cvt_pk_bf16_f32 v54, v140, v141
    v_cvt_pk_bf16_f32 v55, v142, v143
    buffer_store_dwordx4 v[52:55], v18, s[16:19], 0 offen offset:1024 sc1
    v_mul_f32 v144, s34, v144
    v_mul_f32 v145, s34, v145
    v_mul_f32 v146, s34, v146
    v_mul_f32 v147, s34, v147
    v_mul_f32 v148, s34, v148
    v_mul_f32 v149, s34, v149
    v_mul_f32 v150, s34, v150
    v_mul_f32 v151, s34, v151
    v_cvt_pk_bf16_f32 v56, v144, v145
    v_cvt_pk_bf16_f32 v57, v146, v147
    v_cvt_pk_bf16_f32 v58, v148, v149
    v_cvt_pk_bf16_f32 v59, v150, v151
    buffer_store_dwordx4 v[56:59], v19, s[16:19], 0 offen offset:0 sc1
    v_mul_f32 v152, s34, v152
    v_mul_f32 v153, s34, v153
    v_mul_f32 v154, s34, v154
    v_mul_f32 v155, s34, v155
    v_mul_f32 v156, s34, v156
    v_mul_f32 v157, s34, v157
    v_mul_f32 v158, s34, v158
    v_mul_f32 v159, s34, v159
    v_cvt_pk_bf16_f32 v60, v152, v153
    v_cvt_pk_bf16_f32 v61, v154, v155
    v_cvt_pk_bf16_f32 v62, v156, v157
    v_cvt_pk_bf16_f32 v63, v158, v159
    buffer_store_dwordx4 v[60:63], v19, s[16:19], 0 offen offset:1024 sc1
    s_branch C_DONE
C_KST:
    v_mfma_f32_16x16x32_bf16 v[96:99], v[80:83], v[64:67], v[96:99]
    v_mfma_f32_16x16x32_bf16 v[100:103], v[80:83], v[68:71], v[100:103]
    v_mfma_f32_16x16x32_bf16 v[104:107], v[80:83], v[72:75], v[104:107]
    v_mfma_f32_16x16x32_bf16 v[108:111], v[80:83], v[76:79], v[108:111]
    v_mfma_f32_16x16x32_bf16 v[124:127], v[84:87], v[76:79], v[124:127]
    v_mfma_f32_16x16x32_bf16 v[120:123], v[84:87], v[72:75], v[120:123]
    v_mfma_f32_16x16x32_bf16 v[116:119], v[84:87], v[68:71], v[116:119]
    v_mfma_f32_16x16x32_bf16 v[112:115], v[84:87], v[64:67], v[112:115]
    v_mfma_f32_16x16x32_bf16 v[128:131], v[88:91], v[64:67], v[128:131]
    v_cvt_pk_bf16_f32 v32, v96, v97
    v_cvt_pk_bf16_f32 v33, v98, v99
    v_mfma_f32_16x16x32_bf16 v[132:135], v[88:91], v[68:71], v[132:135]
    v_cvt_pk_bf16_f32 v34, v100, v101
    v_cvt_pk_bf16_f32 v35, v102, v103
    v_mfma_f32_16x16x32_bf16 v[136:139], v[88:91], v[72:75], v[136:139]
    buffer_store_dwordx4 v[32:35], v16, s[16:19], 0 offen offset:0 sc1
    v_cvt_pk_bf16_f32 v36, v104, v105
    v_mfma_f32_16x16x32_bf16 v[140:143], v[88:91], v[76:79], v[140:143]
    v_cvt_pk_bf16_f32 v37, v106, v107
    v_cvt_pk_bf16_f32 v38, v108, v109
    v_mfma_f32_16x16x32_bf16 v[156:159], v[92:95], v[76:79], v[156:159]
    v_cvt_pk_bf16_f32 v39, v110, v111
    buffer_store_dwordx4 v[36:39], v16, s[16:19], 0 offen offset:1024 sc1
    v_mfma_f32_16x16x32_bf16 v[152:155], v[92:95], v[72:75], v[152:155]
    v_cvt_pk_bf16_f32 v40, v112, v113
    v_cvt_pk_bf16_f32 v41, v114, v115
    v_mfma_f32_16x16x32_bf16 v[148:151], v[92:95], v[68:71], v[148:151]
    v_cvt_pk_bf16_f32 v42, v116, v117
    v_cvt_pk_bf16_f32 v43, v118, v119
    v_mfma_f32_16x16x32_bf16 v[144:147], v[92:95], v[64:67], v[144:147]
    buffer_store_dwordx4 v[40:43], v17, s[16:19], 0 offen offset:0 sc1
    v_cvt_pk_bf16_f32 v44, v120, v121
    v_cvt_pk_bf16_f32 v45, v122, v123
    v_cvt_pk_bf16_f32 v46, v124, v125
    v_cvt_pk_bf16_f32 v47, v126, v127
    buffer_store_dwordx4 v[44:47], v17, s[16:19], 0 offen offset:1024 sc1
    v_cvt_pk_bf16_f32 v48, v128, v129
    v_cvt_pk_bf16_f32 v49, v130, v131
    v_cvt_pk_bf16_f32 v50, v132, v133
    v_cvt_pk_bf16_f32 v51, v134, v135
    buffer_store_dwordx4 v[48:51], v18, s[16:19], 0 offen offset:0 sc1
    v_cvt_pk_bf16_f32 v52, v136, v137
    v_cvt_pk_bf16_f32 v53, v138, v139
    v_cvt_pk_bf16_f32 v54, v140, v141
    v_cvt_pk_bf16_f32 v55, v142, v143
    buffer_store_dwordx4 v[52:55], v18, s[16:19], 0 offen offset:1024 sc1
    v_cvt_pk_bf16_f32 v56, v144, v145
    v_cvt_pk_bf16_f32 v57, v146, v147
    v_cvt_pk_bf16_f32 v58, v148, v149
    v_cvt_pk_bf16_f32 v59, v150, v151
    buffer_store_dwordx4 v[56:59], v19, s[16:19], 0 offen offset:0 sc1
    v_cvt_pk_bf16_f32 v60, v152, v153
    v_cvt_pk_bf16_f32 v61, v154, v155
    v_cvt_pk_bf16_f32 v62, v156, v157
    v_cvt_pk_bf16_f32 v63, v158, v159
    buffer_store_dwordx4 v[60:63], v19, s[16:19], 0 offen offset:1024 sc1
    s_branch C_DONE
C_V:
    s_sub_u32 s29, s24, 9
    s_lshl_b32 s29, s29, 7
    s_lshl_b32 s30, s27, 6
    s_add_u32 s29, s29, s30
    s_cmp_ge_u32 s29, 576
    s_cbranch_scc1 C_G
    s_lshr_b32 s30, s28, 3
    s_mul_i32 s30, s30, 17408
    s_and_b32 s31, s28, 7
    s_mul_i32 s31, s31, 1152
    s_add_u32 s30, s30, s31
    s_add_u32 s30, s30, 2105344
    s_mov_b32 s36, 139264
    v_add_u32 v41, s29, v14
    v_lshrrev_b32 v45, 1, v15
    v_mul_u32_u24 v45, 576, v45
    v_add_u32 v45, s30, v45
    v_and_b32 v46, 1, v15
    v_add_u32 v42, 0, v41
    v_mul_u32_u24 v43, 3641, v42
    v_lshrrev_b32 v43, 16, v43
    v_mul_u32_u24 v44, 18, v43
    v_sub_u32 v44, v42, v44
    v_mul_lo_u32 v43, v43, s36
    v_lshrrev_b32 v40, 4, v44
    v_xor_b32 v40, v40, v46
    v_lshlrev_b32 v40, 4, v40
    v_lshl_add_u32 v44, v44, 5, v40
    v_add3_u32 v16, v43, v44, v45
    v_add_u32 v42, 16, v41
    v_mul_u32_u24 v43, 3641, v42
    v_lshrrev_b32 v43, 16, v43
    v_mul_u32_u24 v44, 18, v43
    v_sub_u32 v44, v42, v44
    v_mul_lo_u32 v43, v43, s36
    v_lshrrev_b32 v40, 4, v44
    v_xor_b32 v40, v40, v46
    v_lshlrev_b32 v40, 4, v40
    v_lshl_add_u32 v44, v44, 5, v40
    v_add3_u32 v17, v43, v44, v45
    v_add_u32 v42, 32, v41
    v_mul_u32_u24 v43, 3641, v42
    v_lshrrev_b32 v43, 16, v43
    v_mul_u32_u24 v44, 18, v43
    v_sub_u32 v44, v42, v44
    v_mul_lo_u32 v43, v43, s36
    v_lshrrev_b32 v40, 4, v44
    v_xor_b32 v40, v40, v46
    v_lshlrev_b32 v40, 4, v40
    v_lshl_add_u32 v44, v44, 5, v40
    v_add3_u32 v18, v43, v44, v45
    v_add_u32 v42, 48, v41
    v_mul_u32_u24 v43, 3641, v42
    v_lshrrev_b32 v43, 16, v43
    v_mul_u32_u24 v44, 18, v43
    v_sub_u32 v44, v42, v44
    v_mul_lo_u32 v43, v43, s36
    v_lshrrev_b32 v40, 4, v44
    v_xor_b32 v40, v40, v46
    v_lshlrev_b32 v40, 4, v40
    v_lshl_add_u32 v44, v44, 5, v40
    v_add3_u32 v19, v43, v44, v45
    s_barrier
    ds_read_b64_tr_b16 v[48:49], v6 offset:16384
    ds_read_b64_tr_b16 v[50:51], v6 offset:17408
    ds_read_b128 v[32:35], v2 offset:0
    ds_read_b128 v[36:39], v3 offset:0
    ds_read_b128 v[40:43], v2 offset:4096
    ds_read_b128 v[44:47], v3 offset:4096
    ds_read_b64_tr_b16 v[52:53], v7 offset:16384
    ds_read_b64_tr_b16 v[54:55], v7 offset:17408
    ds_read_b64_tr_b16 v[56:57], v8 offset:16384
    ds_read_b64_tr_b16 v[58:59], v8 offset:17408
    ds_read_b64_tr_b16 v[60:61], v9 offset:16384
    ds_read_b64_tr_b16 v[62:63], v9 offset:17408
.p2align 3
CT_V:
    s_waitcnt lgkmcnt(6)
    v_mfma_f32_16x16x32_bf16 v[96:99], v[32:35], v[48:51], v[96:99]
    ds_read_b64_tr_b16 v[80:81], v6 offset:24576
    v_mfma_f32_16x16x32_bf16 v[100:103], v[36:39], v[48:51], v[100:103]
    ds_read_b64_tr_b16 v[82:83], v6 offset:25600
    v_mfma_f32_16x16x32_bf16 v[104:107], v[40:43], v[48:51], v[104:107]
    ds_read_b128 v[64:67], v4 offset:0
    v_mfma_f32_16x16x32_bf16 v[108:111], v[44:47], v[48:51], v[108:111]
    ds_read_b128 v[68:71], v5 offset:0
    s_waitcnt lgkmcnt(8)
    v_mfma_f32_16x16x32_bf16 v[124:127], v[44:47], v[52:55], v[124:127]
    ds_read_b128 v[72:75], v4 offset:4096
    v_mfma_f32_16x16x32_bf16 v[120:123], v[40:43], v[52:55], v[120:123]
    ds_read_b128 v[76:79], v5 offset:4096
    v_mfma_f32_16x16x32_bf16 v[116:119], v[36:39], v[52:55], v[116:119]
    ds_read_b64_tr_b16 v[84:85], v7 offset:24576
    v_mfma_f32_16x16x32_bf16 v[112:115], v[32:35], v[52:55], v[112:115]
    ds_read_b64_tr_b16 v[86:87], v7 offset:25600
    s_waitcnt lgkmcnt(10)
    v_mfma_f32_16x16x32_bf16 v[128:131], v[32:35], v[56:59], v[128:131]
    ds_read_b64_tr_b16 v[88:89], v8 offset:24576
    v_mfma_f32_16x16x32_bf16 v[132:135], v[36:39], v[56:59], v[132:135]
    ds_read_b64_tr_b16 v[90:91], v8 offset:25600
    v_mfma_f32_16x16x32_bf16 v[136:139], v[40:43], v[56:59], v[136:139]
    ds_read_b64_tr_b16 v[92:93], v9 offset:24576
    v_mfma_f32_16x16x32_bf16 v[140:143], v[44:47], v[56:59], v[140:143]
    ds_read_b64_tr_b16 v[94:95], v9 offset:25600
    s_waitcnt lgkmcnt(12)
    v_mfma_f32_16x16x32_bf16 v[156:159], v[44:47], v[60:63], v[156:159]
    s_add_u32 s41, s41, 1
    s_cmp_eq_u32 s41, 3
    v_mfma_f32_16x16x32_bf16 v[152:155], v[40:43], v[60:63], v[152:155]
    s_cselect_b32 s41, 0, s41
    s_cselect_b32 s42, s44, s43
    v_mfma_f32_16x16x32_bf16 v[148:151], v[36:39], v[60:63], v[148:151]
    v_add_u32 v2, s42, v2
    v_add_u32 v3, s42, v3
    v_mfma_f32_16x16x32_bf16 v[144:147], v[32:35], v[60:63], v[144:147]
    s_add_u32 s40, s40, 1
    s_cmp_eq_u32 s40, 10
    s_waitcnt lgkmcnt(0)
    s_cbranch_scc1 CE_V
    v_mfma_f32_16x16x32_bf16 v[96:99], v[64:67], v[80:83], v[96:99]
    v_add_u32 v6, s42, v6
    v_add_u32 v7, s42, v7
    v_mfma_f32_16x16x32_bf16 v[100:103], v[68:71], v[80:83], v[100:103]
    s_barrier
    v_mfma_f32_16x16x32_bf16 v[104:107], v[72:75], v[80:83], v[104:107]
    ds_read_b64_tr_b16 v[48:49], v6 offset:16384
    v_mfma_f32_16x16x32_bf16 v[108:111], v[76:79], v[80:83], v[108:111]
    ds_read_b64_tr_b16 v[50:51], v6 offset:17408
    v_add_u32 v8, s42, v8
    v_mfma_f32_16x16x32_bf16 v[124:127], v[76:79], v[84:87], v[124:127]
    ds_read_b128 v[32:35], v2 offset:0
    v_mfma_f32_16x16x32_bf16 v[120:123], v[72:75], v[84:87], v[120:123]
    ds_read_b128 v[36:39], v3 offset:0
    v_add_u32 v9, s42, v9
    v_mfma_f32_16x16x32_bf16 v[116:119], v[68:71], v[84:87], v[116:119]
    ds_read_b128 v[40:43], v2 offset:4096
    v_mfma_f32_16x16x32_bf16 v[112:115], v[64:67], v[84:87], v[112:115]
    ds_read_b128 v[44:47], v3 offset:4096
    v_mfma_f32_16x16x32_bf16 v[128:131], v[64:67], v[88:91], v[128:131]
    ds_read_b64_tr_b16 v[52:53], v7 offset:16384
    v_mfma_f32_16x16x32_bf16 v[132:135], v[68:71], v[88:91], v[132:135]
    ds_read_b64_tr_b16 v[54:55], v7 offset:17408
    v_mfma_f32_16x16x32_bf16 v[136:139], v[72:75], v[88:91], v[136:139]
    ds_read_b64_tr_b16 v[56:57], v8 offset:16384
    v_mfma_f32_16x16x32_bf16 v[140:143], v[76:79], v[88:91], v[140:143]
    ds_read_b64_tr_b16 v[58:59], v8 offset:17408
    v_mfma_f32_16x16x32_bf16 v[156:159], v[76:79], v[92:95], v[156:159]
    ds_read_b64_tr_b16 v[60:61], v9 offset:16384
    v_mfma_f32_16x16x32_bf16 v[152:155], v[72:75], v[92:95], v[152:155]
    ds_read_b64_tr_b16 v[62:63], v9 offset:17408
    v_mfma_f32_16x16x32_bf16 v[148:151], v[68:71], v[92:95], v[148:151]
    v_add_u32 v4, s42, v4
    v_add_u32 v5, s42, v5
    v_mfma_f32_16x16x32_bf16 v[144:147], v[64:67], v[92:95], v[144:147]
    s_branch CT_V
CE_V:
    s_setprio 3
    v_mfma_f32_16x16x32_bf16 v[96:99], v[64:67], v[80:83], v[96:99]
    v_mfma_f32_16x16x32_bf16 v[100:103], v[68:71], v[80:83], v[100:103]
    v_mfma_f32_16x16x32_bf16 v[104:107], v[72:75], v[80:83], v[104:107]
    v_mfma_f32_16x16x32_bf16 v[108:111], v[76:79], v[80:83], v[108:111]
    v_mfma_f32_16x16x32_bf16 v[124:127], v[76:79], v[84:87], v[124:127]
    v_mfma_f32_16x16x32_bf16 v[120:123], v[72:75], v[84:87], v[120:123]
    v_mfma_f32_16x16x32_bf16 v[116:119], v[68:71], v[84:87], v[116:119]
    v_mfma_f32_16x16x32_bf16 v[112:115], v[64:67], v[84:87], v[112:115]
    v_mfma_f32_16x16x32_bf16 v[128:131], v[64:67], v[88:91], v[128:131]
    v_cvt_pk_bf16_f32 v32, v96, v97
    v_cvt_pk_bf16_f32 v33, v98, v99
    v_mfma_f32_16x16x32_bf16 v[132:135], v[68:71], v[88:91], v[132:135]
    v_cvt_pk_bf16_f32 v34, v100, v101
    v_cvt_pk_bf16_f32 v35, v102, v103
    v_mfma_f32_16x16x32_bf16 v[136:139], v[72:75], v[88:91], v[136:139]
    buffer_store_dwordx4 v[32:35], v16, s[16:19], 0 offen offset:0 sc1
    v_cvt_pk_bf16_f32 v36, v104, v105
    v_mfma_f32_16x16x32_bf16 v[140:143], v[76:79], v[88:91], v[140:143]
    v_cvt_pk_bf16_f32 v37, v106, v107
    v_cvt_pk_bf16_f32 v38, v108, v109
    v_mfma_f32_16x16x32_bf16 v[156:159], v[76:79], v[92:95], v[156:159]
    v_cvt_pk_bf16_f32 v39, v110, v111
    buffer_store_dwordx4 v[36:39], v16, s[16:19], 0 offen offset:1152 sc1
    v_mfma_f32_16x16x32_bf16 v[152:155], v[72:75], v[92:95], v[152:155]
    v_cvt_pk_bf16_f32 v40, v112, v113
    v_cvt_pk_bf16_f32 v41, v114, v115
    v_mfma_f32_16x16x32_bf16 v[148:151], v[68:71], v[92:95], v[148:151]
    v_cvt_pk_bf16_f32 v42, v116, v117
    v_cvt_pk_bf16_f32 v43, v118, v119
    v_mfma_f32_16x16x32_bf16 v[144:147], v[64:67], v[92:95], v[144:147]
    buffer_store_dwordx4 v[40:43], v17, s[16:19], 0 offen offset:0 sc1
    v_cvt_pk_bf16_f32 v44, v120, v121
    v_cvt_pk_bf16_f32 v45, v122, v123
    v_cvt_pk_bf16_f32 v46, v124, v125
    v_cvt_pk_bf16_f32 v47, v126, v127
    buffer_store_dwordx4 v[44:47], v17, s[16:19], 0 offen offset:1152 sc1
    v_cvt_pk_bf16_f32 v48, v128, v129
    v_cvt_pk_bf16_f32 v49, v130, v131
    v_cvt_pk_bf16_f32 v50, v132, v133
    v_cvt_pk_bf16_f32 v51, v134, v135
    buffer_store_dwordx4 v[48:51], v18, s[16:19], 0 offen offset:0 sc1
    v_cvt_pk_bf16_f32 v52, v136, v137
    v_cvt_pk_bf16_f32 v53, v138, v139
    v_cvt_pk_bf16_f32 v54, v140, v141
    v_cvt_pk_bf16_f32 v55, v142, v143
    buffer_store_dwordx4 v[52:55], v18, s[16:19], 0 offen offset:1152 sc1
    v_cvt_pk_bf16_f32 v56, v144, v145
    v_cvt_pk_bf16_f32 v57, v146, v147
    v_cvt_pk_bf16_f32 v58, v148, v149
    v_cvt_pk_bf16_f32 v59, v150, v151
    buffer_store_dwordx4 v[56:59], v19, s[16:19], 0 offen offset:0 sc1
    v_cvt_pk_bf16_f32 v60, v152, v153
    v_cvt_pk_bf16_f32 v61, v154, v155
    v_cvt_pk_bf16_f32 v62, v156, v157
    v_cvt_pk_bf16_f32 v63, v158, v159
    buffer_store_dwordx4 v[60:63], v19, s[16:19], 0 offen offset:1152 sc1
C_DONE:
    s_waitcnt lgkmcnt(0)
    s_load_dword s60, s[6:7], 0
    s_waitcnt lgkmcnt(0)
    s_cmp_lg_u32 s60, 0
    s_cbranch_scc1 ND_C
    v_mov_b32 v24, 0
    global_load_dword v25, v24, s[6:7] sc1
    s_mov_b32 s65, 20000
NL_C:
    s_waitcnt vmcnt(0)
    v_readfirstlane_b32 s60, v25
    s_nop 0
    s_cmp_lg_u32 s60, 0
    s_cbranch_scc1 ND_C
    s_sleep 2
    global_load_dword v25, v24, s[6:7] sc1
    s_sub_u32 s65, s65, 1
    s_cmp_lg_u32 s65, 0
    s_cbranch_scc1 NL_C
    s_waitcnt vmcnt(0)
ND_C:
    s_waitcnt vmcnt(0)
    s_mov_b64 exec, 1
    ds_add_rtn_u32 v28, v26, v27
    s_mov_b64 exec, -1
    s_waitcnt lgkmcnt(0)
    v_readfirstlane_b32 s29, v28
    s_nop 0
    s_cmp_lg_u32 s29, 3
    s_cbranch_scc1 F_ATT
    v_mov_b32 v26, s60
    s_mov_b64 exec, s[52:53]
    buffer_atomic_swap v26, v12, s[16:19], 0 offen sc1
    s_mov_b64 exec, -1
    s_branch F_ATT
C_G:
    s_mov_b32 s48, s4
    s_mov_b32 s49, s5
    s_mov_b32 s50, 1152
    s_mov_b32 s51, 0x00020000
    s_lshl_b32 s29, s26, 11
    s_add_u32 s29, s29, 142336
    s_mov_b32 m0, s29
    v_lshlrev_b32 v16, 4, v1
    v_lshl_add_u32 v17, v15, 4, s29
    buffer_load_dwordx4 v16, s[48:51], 0 offen lds
    buffer_load_dwordx4 v16, s[48:51], 0 offen offset:1024 lds
    s_waitcnt vmcnt(0)
    s_barrier
C_GL:
    s_lshl_b32 s29, s25, 7
    v_add_u32 v18, s29, v17
    ds_read_b128 v[32:35], v2 offset:0
    ds_read_b128 v[36:39], v3 offset:0
    ds_read_b128 v[40:43], v2 offset:4096
    ds_read_b128 v[44:47], v3 offset:4096
    ds_read_b128 v[48:51], v18 offset:0
    ds_read_b128 v[52:55], v4 offset:0
    ds_read_b128 v[56:59], v5 offset:0
    ds_read_b128 v[60:63], v4 offset:4096
    ds_read_b128 v[64:67], v5 offset:4096
    ds_read_b128 v[68:71], v18 offset:64
    s_add_u32 s25, s25, 1
    s_cmp_eq_u32 s25, 9
    s_cselect_b32 s25, 0, s25
    s_add_u32 s41, s41, 1
    s_cmp_eq_u32 s41, 3
    s_cselect_b32 s41, 0, s41
    s_cselect_b32 s42, s44, s43
    v_add_u32 v2, s42, v2
    v_add_u32 v3, s42, v3
    v_add_u32 v4, s42, v4
    v_add_u32 v5, s42, v5
    s_cmp_eq_u32 s40, 9
    s_waitcnt lgkmcnt(0)
    s_cbranch_scc1 C_GN
    s_barrier
C_GN:
    v_mfma_f32_16x16x32_bf16 v[96:99], v[48:51], v[32:35], v[96:99]
    v_mfma_f32_16x16x32_bf16 v[100:103], v[48:51], v[36:39], v[100:103]
    v_mfma_f32_16x16x32_bf16 v[104:107], v[48:51], v[40:43], v[104:107]
    v_mfma_f32_16x16x32_bf16 v[108:111], v[48:51], v[44:47], v[108:111]
    v_mfma_f32_16x16x32_bf16 v[96:99], v[68:71], v[52:55], v[96:99]
    v_mfma_f32_16x16x32_bf16 v[100:103], v[68:71], v[56:59], v[100:103]
    v_mfma_f32_16x16x32_bf16 v[104:107], v[68:71], v[60:63], v[104:107]
    v_mfma_f32_16x16x32_bf16 v[108:111], v[68:71], v[64:67], v[108:111]
    s_add_u32 s40, s40, 1
    s_cmp_lt_u32 s40, 10
    s_cbranch_scc1 C_GL
    s_mov_b32 s30, 0xffff0000
    s_mov_b32 s31, s30
    s_mov_b32 s32, 0
    s_mov_b32 s33, -1
    v_lshrrev_b32 v16, 1, v15
    v_lshl_add_u32 v16, v16, 5, v19
    v_and_b32 v17, 1, v15
    v_lshl_add_u32 v16, v17, 2, v16
    v_lshlrev_b32 v16, 3, v16
    s_lshl_b32 s29, s28, 8
    s_add_u32 s29, s29, 15765504
    v_cndmask_b32 v20, v96, v100, s[30:31]
    v_cndmask_b32 v21, v104, v108, s[30:31]
    v_cndmask_b32 v20, v20, v21, s[32:33]
    v_cvt_pk_bf16_f32 v20, v20, v20
    v_and_b32 v20, 0xffff0000, v20
    v_mul_f32 v20, 0xbfb8aa3b, v20
    v_exp_f32 v20, v20
    s_nop 0
    v_add_f32 v20, 1.0, v20
    v_rcp_f32 v20, v20
    s_nop 0
    v_cvt_pk_bf16_f32 v20, v20, v20
    v_and_b32 v20, 0xffff0000, v20
    v_sub_f32 v21, 1.0, v20
    v_cvt_pk_bf16_f32 v21, v21, v21
    v_and_b32 v21, 0xffff0000, v21
    buffer_store_dwordx2 v[20:21], v16, s[16:19], s29 offen sc1
    s_branch C_DONE
F_D:
    s_and_b32 s61, s22, 3
    s_lshl_b32 s63, s21, 2
    s_add_u32 s61, s61, s63
    s_lshr_b32 s62, s22, 2
    s_lshr_b32 s64, s22, 3
    s_add_u32 s63, s63, s64
    s_and_b32 s64, s22, 7
    s_sub_u32 s59, s20, 4
    s_cmp_lt_u32 s22, 28
    s_cselect_b32 s58, 0, 4
    s_xor_b32 s59, s59, s58
    s_and_b32 s58, s62, 0
    s_setprio 3
    v_mov_b32 v2, 163584
    v_lshlrev_b32 v3, 4, v1
    v_and_b32 v8, 31, v1
    v_lshlrev_b32 v8, 3, v8
    v_lshrrev_b32 v9, 5, v1
    v_lshl_add_u32 v26, v9, 10, v8
    v_add_u32 v27, 1792, v26
    v_add_u32 v28, 3584, v26
    v_add_u32 v29, 5376, v26
    s_mul_i32 s36, s61, 139264
    s_add_u32 s36, s36, 2097152
    s_lshr_b32 s37, s61, 1
    s_lshl_b32 s37, s37, 16
    s_and_b32 s38, s61, 1
    s_lshl_b32 s38, s38, 2
    s_add_u32 s37, s37, s38
    s_add_u32 s37, s37, 14716928
    s_add_u32 s38, s58, 2
    s_and_b32 s38, s38, 7
    v_and_b32 v38, 3, v1
    v_lshl_add_u32 v38, v38, 2, v2
    s_mul_i32 s70, s61, 18
    s_and_b32 s71, s61, 1
    s_lshl_b32 s71, s71, 1
    s_sub_u32 s71, s70, s71
    s_and_b32 s72, s71, 127
    s_cmp_ge_u32 s72, 109
    s_cselect_b32 s72, 15, 3
    s_mov_b32 s73, 0
    s_add_u32 s74, s71, 576
    s_and_b32 s74, s74, 127
    s_cmp_ge_u32 s74, 109
    s_cselect_b32 s74, -1, 0xffff
    s_and_b32 s75, s70, 127
    s_cmp_ge_u32 s75, 111
    s_cselect_b32 s75, -1, 0xffff
    s_mul_i32 s76, s61, 512
    s_add_u32 s76, s76, 15782016
    v_lshl_add_u32 v39, v1, 2, s76
    s_mov_b32 s65, 160000
LL_DQ:
    ds_read_b32 v36, v2 offset:4
    s_waitcnt lgkmcnt(0)
    v_readfirstlane_b32 s66, v36
    s_nop 0
    s_cmp_ge_u32 s66, 1
    s_cbranch_scc1 LD_DQ
    s_sleep 1
    s_sub_u32 s65, s65, 1
    s_cmp_lg_u32 s65, 0
    s_cbranch_scc1 LL_DQ
LD_DQ:
    s_mov_b32 s65, 20000
PL_DK:
    s_mov_b64 exec, s[74:75]
    v_mov_b32 v36, 0
    buffer_atomic_or v36, v39, s[16:19], 0 offen sc0 sc1
    s_waitcnt vmcnt(0)
    s_mov_b64 exec, s[74:75]
    v_cmp_ne_u32 s[66:67], s60, v36
    s_mov_b64 exec, -1
    s_cmp_eq_u64 s[66:67], 0
    s_cbranch_scc1 PD_DK
    s_sleep 1
    s_sub_u32 s65, s65, 1
    s_cmp_lg_u32 s65, 0
    s_cbranch_scc1 PL_DK
PD_DK:
    v_and_b32 v37, 7, v1
    v_lshl_add_u32 v37, v37, 2, v2
    s_mov_b32 s65, 160000
LL_DR:
    ds_read_b32 v36, v37 offset:48
    s_waitcnt lgkmcnt(0)
    v_cmp_gt_u32 s[66:67], 1, v36
    s_nop 0
    s_cmp_eq_u64 s[66:67], 0
    s_cbranch_scc1 LD_DR
    s_sleep 1
    s_sub_u32 s65, s65, 1
    s_cmp_lg_u32 s65, 0
    s_cbranch_scc1 LL_DR
LD_DR:
    s_cmp_lt_u32 s22, 28
    s_cbranch_scc1 D_NX
    s_lshl_b32 s28, s31, 7
    s_add_u32 s28, s28, 15800576
    v_lshlrev_b32 v8, 7, v1
    v_mov_b32 v9, s60
    s_mov_b64 exec, 3
    buffer_store_dword v9, v8, s[16:19], s28 offen sc1
    s_mov_b64 exec, -1
    s_waitcnt vmcnt(0)
    s_mov_b32 s65, 160000
LL_CX:
    ds_read_b32 v36, v38 offset:80
    s_waitcnt lgkmcnt(0)
    v_cmp_gt_u32 s[66:67], 4, v36
    s_nop 0
    s_cmp_eq_u64 s[66:67], 0
    s_cbranch_scc1 LD_CX
    s_sleep 2
    s_sub_u32 s65, s65, 1
    s_cmp_lg_u32 s65, 0
    s_cbranch_scc1 LL_CX
LD_CX:
D_NX:
    s_mul_i32 s40, s38, 17408
    s_add_u32 s40, s40, s36
    s_lshl_b32 s41, s38, 13
    s_add_u32 s41, s41, s37
    s_mov_b32 m0, 45056
    s_add_u32 s38, s38, 1
    buffer_load_dword v26, s[16:19], s41 offen offset:0 sc1 lds
    buffer_load_dword v27, s[16:19], s41 offen offset:256 sc1 lds
    buffer_load_dword v28, s[16:19], s41 offen offset:512 sc1 lds
    buffer_load_dword v29, s[16:19], s41 offen offset:768 sc1 lds
    s_mov_b32 m0, 36864
    s_add_u32 s42, s40, 0
    buffer_load_dwordx4 v3, s[16:19], s42 offen offset:0 sc1 lds
    buffer_load_dwordx4 v3, s[16:19], s42 offen offset:1024 sc1 lds
    buffer_load_dwordx4 v3, s[16:19], s42 offen offset:2048 sc1 lds
    buffer_load_dwordx4 v3, s[16:19], s42 offen offset:3072 sc1 lds
    s_mov_b32 m0, 46080
    s_add_u32 s42, s40, 8192
    buffer_load_dwordx4 v3, s[16:19], s42 offen offset:0 sc1 lds
    buffer_load_dwordx4 v3, s[16:19], s42 offen offset:1024 sc1 lds
    buffer_load_dwordx4 v3, s[16:19], s42 offen offset:2048 sc1 lds
    buffer_load_dwordx4 v3, s[16:19], s42 offen offset:3072 sc1 lds
    s_mov_b32 m0, 40960
    s_add_u32 s42, s40, 4096
    buffer_load_dwordx4 v3, s[16:19], s42 offen offset:0 sc1 lds
    buffer_load_dwordx4 v3, s[16:19], s42 offen offset:1024 sc1 lds
    buffer_load_dwordx4 v3, s[16:19], s42 offen offset:2048 sc1 lds
    buffer_load_dwordx4 v3, s[16:19], s42 offen offset:3072 sc1 lds
    s_mov_b32 m0, 50176
    s_add_u32 s42, s40, 12288
    buffer_load_dwordx4 v3, s[16:19], s42 offen offset:0 sc1 lds
    buffer_load_dwordx4 v3, s[16:19], s42 offen offset:1024 sc1 lds
    buffer_load_dwordx4 v3, s[16:19], s42 offen offset:2048 sc1 lds
    buffer_load_dwordx4 v3, s[16:19], s42 offen offset:3072 sc1 lds
    s_mov_b32 m0, 54272
    s_add_u32 s42, s40, 16384
    buffer_load_dwordx4 v3, s[16:19], s42 offen offset:0 sc1 lds
    s_and_b32 s38, s38, 7
    v_mov_b32 v31, 3
    s_waitcnt vmcnt(0)
    ds_write_b32 v2, v31 offset:8
    v_mov_b32 v31, 5
    ds_write_b32 v2, v31 offset:80
    s_waitcnt lgkmcnt(0)
    s_mul_i32 s40, s38, 17408
    s_add_u32 s40, s40, s36
    s_lshl_b32 s41, s38, 13
    s_add_u32 s41, s41, s37
    s_mov_b32 m0, 63488
    s_add_u32 s38, s38, 1
    buffer_load_dword v26, s[16:19], s41 offen offset:0 sc1 lds
    buffer_load_dword v27, s[16:19], s41 offen offset:256 sc1 lds
    buffer_load_dword v28, s[16:19], s41 offen offset:512 sc1 lds
    buffer_load_dword v29, s[16:19], s41 offen offset:768 sc1 lds
    s_mov_b32 m0, 55296
    s_add_u32 s42, s40, 0
    buffer_load_dwordx4 v3, s[16:19], s42 offen offset:0 sc1 lds
    buffer_load_dwordx4 v3, s[16:19], s42 offen offset:1024 sc1 lds
    buffer_load_dwordx4 v3, s[16:19], s42 offen offset:2048 sc1 lds
    buffer_load_dwordx4 v3, s[16:19], s42 offen offset:3072 sc1 lds
    s_mov_b32 m0, 64512
    s_add_u32 s42, s40, 8192
    buffer_load_dwordx4 v3, s[16:19], s42 offen offset:0 sc1 lds
    buffer_load_dwordx4 v3, s[16:19], s42 offen offset:1024 sc1 lds
    buffer_load_dwordx4 v3, s[16:19], s42 offen offset:2048 sc1 lds
    buffer_load_dwordx4 v3, s[16:19], s42 offen offset:3072 sc1 lds
    s_mov_b32 m0, 59392
    s_add_u32 s42, s40, 4096
    buffer_load_dwordx4 v3, s[16:19], s42 offen offset:0 sc1 lds
    buffer_load_dwordx4 v3, s[16:19], s42 offen offset:1024 sc1 lds
    buffer_load_dwordx4 v3, s[16:19], s42 offen offset:2048 sc1 lds
    buffer_load_dwordx4 v3, s[16:19], s42 offen offset:3072 sc1 lds
    s_mov_b32 m0, 68608
    s_add_u32 s42, s40, 12288
    buffer_load_dwordx4 v3, s[16:19], s42 offen offset:0 sc1 lds
    buffer_load_dwordx4 v3, s[16:19], s42 offen offset:1024 sc1 lds
    buffer_load_dwordx4 v3, s[16:19], s42 offen offset:2048 sc1 lds
    buffer_load_dwordx4 v3, s[16:19], s42 offen offset:3072 sc1 lds
    s_mov_b32 m0, 72704
    s_add_u32 s42, s40, 16384
    buffer_load_dwordx4 v3, s[16:19], s42 offen offset:0 sc1 lds
    s_and_b32 s38, s38, 7
    s_mul_i32 s40, s38, 17408
    s_add_u32 s40, s40, s36
    s_lshl_b32 s41, s38, 13
    s_add_u32 s41, s41, s37
    s_mov_b32 m0, 81920
    s_add_u32 s38, s38, 1
    buffer_load_dword v26, s[16:19], s41 offen offset:0 sc1 lds
    buffer_load_dword v27, s[16:19], s41 offen offset:256 sc1 lds
    buffer_load_dword v28, s[16:19], s41 offen offset:512 sc1 lds
    buffer_load_dword v29, s[16:19], s41 offen offset:768 sc1 lds
    s_mov_b32 m0, 73728
    s_add_u32 s42, s40, 0
    buffer_load_dwordx4 v3, s[16:19], s42 offen offset:0 sc1 lds
    buffer_load_dwordx4 v3, s[16:19], s42 offen offset:1024 sc1 lds
    buffer_load_dwordx4 v3, s[16:19], s42 offen offset:2048 sc1 lds
    buffer_load_dwordx4 v3, s[16:19], s42 offen offset:3072 sc1 lds
    s_mov_b32 m0, 82944
    s_add_u32 s42, s40, 8192
    buffer_load_dwordx4 v3, s[16:19], s42 offen offset:0 sc1 lds
    buffer_load_dwordx4 v3, s[16:19], s42 offen offset:1024 sc1 lds
    buffer_load_dwordx4 v3, s[16:19], s42 offen offset:2048 sc1 lds
    buffer_load_dwordx4 v3, s[16:19], s42 offen offset:3072 sc1 lds
    s_mov_b32 m0, 77824
    s_add_u32 s42, s40, 4096
    buffer_load_dwordx4 v3, s[16:19], s42 offen offset:0 sc1 lds
    buffer_load_dwordx4 v3, s[16:19], s42 offen offset:1024 sc1 lds
    buffer_load_dwordx4 v3, s[16:19], s42 offen offset:2048 sc1 lds
    buffer_load_dwordx4 v3, s[16:19], s42 offen offset:3072 sc1 lds
    s_mov_b32 m0, 87040
    s_add_u32 s42, s40, 12288
    buffer_load_dwordx4 v3, s[16:19], s42 offen offset:0 sc1 lds
    buffer_load_dwordx4 v3, s[16:19], s42 offen offset:1024 sc1 lds
    buffer_load_dwordx4 v3, s[16:19], s42 offen offset:2048 sc1 lds
    buffer_load_dwordx4 v3, s[16:19], s42 offen offset:3072 sc1 lds
    s_mov_b32 m0, 91136
    s_add_u32 s42, s40, 16384
    buffer_load_dwordx4 v3, s[16:19], s42 offen offset:0 sc1 lds
    s_and_b32 s38, s38, 7
    v_mov_b32 v31, 5
    s_waitcnt vmcnt(0)
    ds_write_b32 v2, v31 offset:8
    s_mov_b32 s65, 160000
LL_CV:
    ds_read_b32 v36, v38 offset:80
    s_waitcnt lgkmcnt(0)
    v_cmp_gt_u32 s[66:67], 4, v36
    s_nop 0
    s_cmp_eq_u64 s[66:67], 0
    s_cbranch_scc1 LD_CV
    s_sleep 4
    s_sub_u32 s65, s65, 1
    s_cmp_lg_u32 s65, 0
    s_cbranch_scc1 LL_CV
LD_CV:
    s_mul_i32 s40, s38, 17408
    s_add_u32 s40, s40, s36
    s_lshl_b32 s41, s38, 13
    s_add_u32 s41, s41, s37
    s_mov_b32 m0, 100352
    s_add_u32 s38, s38, 1
    buffer_load_dword v26, s[16:19], s41 offen offset:0 sc1 lds
    buffer_load_dword v27, s[16:19], s41 offen offset:256 sc1 lds
    buffer_load_dword v28, s[16:19], s41 offen offset:512 sc1 lds
    buffer_load_dword v29, s[16:19], s41 offen offset:768 sc1 lds
    s_mov_b32 m0, 92160
    s_add_u32 s42, s40, 0
    buffer_load_dwordx4 v3, s[16:19], s42 offen offset:0 sc1 lds
    buffer_load_dwordx4 v3, s[16:19], s42 offen offset:1024 sc1 lds
    buffer_load_dwordx4 v3, s[16:19], s42 offen offset:2048 sc1 lds
    buffer_load_dwordx4 v3, s[16:19], s42 offen offset:3072 sc1 lds
    s_mov_b32 m0, 101376
    s_add_u32 s42, s40, 8192
    buffer_load_dwordx4 v3, s[16:19], s42 offen offset:0 sc1 lds
    buffer_load_dwordx4 v3, s[16:19], s42 offen offset:1024 sc1 lds
    buffer_load_dwordx4 v3, s[16:19], s42 offen offset:2048 sc1 lds
    buffer_load_dwordx4 v3, s[16:19], s42 offen offset:3072 sc1 lds
    s_mov_b32 m0, 96256
    s_add_u32 s42, s40, 4096
    buffer_load_dwordx4 v3, s[16:19], s42 offen offset:0 sc1 lds
    buffer_load_dwordx4 v3, s[16:19], s42 offen offset:1024 sc1 lds
    buffer_load_dwordx4 v3, s[16:19], s42 offen offset:2048 sc1 lds
    buffer_load_dwordx4 v3, s[16:19], s42 offen offset:3072 sc1 lds
    s_mov_b32 m0, 105472
    s_add_u32 s42, s40, 12288
    buffer_load_dwordx4 v3, s[16:19], s42 offen offset:0 sc1 lds
    buffer_load_dwordx4 v3, s[16:19], s42 offen offset:1024 sc1 lds
    buffer_load_dwordx4 v3, s[16:19], s42 offen offset:2048 sc1 lds
    buffer_load_dwordx4 v3, s[16:19], s42 offen offset:3072 sc1 lds
    s_mov_b32 m0, 109568
    s_add_u32 s42, s40, 16384
    buffer_load_dwordx4 v3, s[16:19], s42 offen offset:0 sc1 lds
    s_and_b32 s38, s38, 7
    s_mul_i32 s40, s38, 17408
    s_add_u32 s40, s40, s36
    s_lshl_b32 s41, s38, 13
    s_add_u32 s41, s41, s37
    s_mov_b32 m0, 118784
    s_add_u32 s38, s38, 1
    buffer_load_dword v26, s[16:19], s41 offen offset:0 sc1 lds
    buffer_load_dword v27, s[16:19], s41 offen offset:256 sc1 lds
    buffer_load_dword v28, s[16:19], s41 offen offset:512 sc1 lds
    buffer_load_dword v29, s[16:19], s41 offen offset:768 sc1 lds
    s_mov_b32 m0, 110592
    s_add_u32 s42, s40, 0
    buffer_load_dwordx4 v3, s[16:19], s42 offen offset:0 sc1 lds
    buffer_load_dwordx4 v3, s[16:19], s42 offen offset:1024 sc1 lds
    buffer_load_dwordx4 v3, s[16:19], s42 offen offset:2048 sc1 lds
    buffer_load_dwordx4 v3, s[16:19], s42 offen offset:3072 sc1 lds
    s_mov_b32 m0, 119808
    s_add_u32 s42, s40, 8192
    buffer_load_dwordx4 v3, s[16:19], s42 offen offset:0 sc1 lds
    buffer_load_dwordx4 v3, s[16:19], s42 offen offset:1024 sc1 lds
    buffer_load_dwordx4 v3, s[16:19], s42 offen offset:2048 sc1 lds
    buffer_load_dwordx4 v3, s[16:19], s42 offen offset:3072 sc1 lds
    s_mov_b32 m0, 114688
    s_add_u32 s42, s40, 4096
    buffer_load_dwordx4 v3, s[16:19], s42 offen offset:0 sc1 lds
    buffer_load_dwordx4 v3, s[16:19], s42 offen offset:1024 sc1 lds
    buffer_load_dwordx4 v3, s[16:19], s42 offen offset:2048 sc1 lds
    buffer_load_dwordx4 v3, s[16:19], s42 offen offset:3072 sc1 lds
    s_mov_b32 m0, 123904
    s_add_u32 s42, s40, 12288
    buffer_load_dwordx4 v3, s[16:19], s42 offen offset:0 sc1 lds
    buffer_load_dwordx4 v3, s[16:19], s42 offen offset:1024 sc1 lds
    buffer_load_dwordx4 v3, s[16:19], s42 offen offset:2048 sc1 lds
    buffer_load_dwordx4 v3, s[16:19], s42 offen offset:3072 sc1 lds
    s_mov_b32 m0, 128000
    s_add_u32 s42, s40, 16384
    buffer_load_dwordx4 v3, s[16:19], s42 offen offset:0 sc1 lds
    s_and_b32 s38, s38, 7
    s_mul_i32 s40, s38, 17408
    s_add_u32 s40, s40, s36
    s_lshl_b32 s41, s38, 13
    s_add_u32 s41, s41, s37
    s_mov_b32 m0, 137216
    s_add_u32 s38, s38, 1
    buffer_load_dword v26, s[16:19], s41 offen offset:0 sc1 lds
    buffer_load_dword v27, s[16:19], s41 offen offset:256 sc1 lds
    buffer_load_dword v28, s[16:19], s41 offen offset:512 sc1 lds
    buffer_load_dword v29, s[16:19], s41 offen offset:768 sc1 lds
    s_mov_b32 m0, 129024
    s_add_u32 s42, s40, 0
    buffer_load_dwordx4 v3, s[16:19], s42 offen offset:0 sc1 lds
    buffer_load_dwordx4 v3, s[16:19], s42 offen offset:1024 sc1 lds
    buffer_load_dwordx4 v3, s[16:19], s42 offen offset:2048 sc1 lds
    buffer_load_dwordx4 v3, s[16:19], s42 offen offset:3072 sc1 lds
    s_mov_b32 m0, 138240
    s_add_u32 s42, s40, 8192
    buffer_load_dwordx4 v3, s[16:19], s42 offen offset:0 sc1 lds
    buffer_load_dwordx4 v3, s[16:19], s42 offen offset:1024 sc1 lds
    buffer_load_dwordx4 v3, s[16:19], s42 offen offset:2048 sc1 lds
    buffer_load_dwordx4 v3, s[16:19], s42 offen offset:3072 sc1 lds
    s_mov_b32 m0, 133120
    s_add_u32 s42, s40, 4096
    buffer_load_dwordx4 v3, s[16:19], s42 offen offset:0 sc1 lds
    buffer_load_dwordx4 v3, s[16:19], s42 offen offset:1024 sc1 lds
    buffer_load_dwordx4 v3, s[16:19], s42 offen offset:2048 sc1 lds
    buffer_load_dwordx4 v3, s[16:19], s42 offen offset:3072 sc1 lds
    s_mov_b32 m0, 142336
    s_add_u32 s42, s40, 12288
    buffer_load_dwordx4 v3, s[16:19], s42 offen offset:0 sc1 lds
    buffer_load_dwordx4 v3, s[16:19], s42 offen offset:1024 sc1 lds
    buffer_load_dwordx4 v3, s[16:19], s42 offen offset:2048 sc1 lds
    buffer_load_dwordx4 v3, s[16:19], s42 offen offset:3072 sc1 lds
    s_mov_b32 m0, 146432
    s_add_u32 s42, s40, 16384
    buffer_load_dwordx4 v3, s[16:19], s42 offen offset:0 sc1 lds
    s_and_b32 s38, s38, 7
    s_load_dwordx2 s[12:13], s[0:1], 88
    s_mov_b32 s14, 663552
    s_mul_i32 s28, s64, 72
    v_add_u32 v8, s28, v1
    v_lshlrev_b32 v8, 7, v8
    v_add_u32 v14, 15800320, v8
    v_add_u32 v15, 1024, v14
    s_lshr_b32 s28, s63, 1
    s_lshl_b32 s28, s28, 7
    s_add_u32 s28, s28, 15798272
    v_writelane_b32 v15, s28, 0
    s_lshl_b32 s28, s62, 8
    s_add_u32 s28, s28, 15798272
    v_writelane_b32 v15, s28, 1
    s_add_u32 s28, s28, 128
    v_writelane_b32 v15, s28, 2
    v_lshrrev_b32 v8, 3, v1
    v_and_b32 v9, 7, v1
    v_xor_b32 v9, v9, v8
    v_lshlrev_b32 v9, 4, v9
    v_lshl_add_u32 v30, v8, 12, v9
    v_add_u32 v8, 0, v1
    v_mul_u32_u24 v9, 7282, v8
    v_lshrrev_b32 v9, 16, v9
    v_mul_u32_u24 v10, 1008, v9
    v_lshl_add_u32 v16, v8, 4, v10
    v_add_u32 v8, 64, v1
    v_mul_u32_u24 v9, 7282, v8
    v_lshrrev_b32 v9, 16, v9
    v_mul_u32_u24 v10, 1008, v9
    v_lshl_add_u32 v17, v8, 4, v10
    v_subrev_u32 v17, 1024, v17
    v_add_u32 v8, 128, v1
    v_mul_u32_u24 v9, 7282, v8
    v_lshrrev_b32 v9, 16, v9
    v_mul_u32_u24 v10, 1008, v9
    v_lshl_add_u32 v18, v8, 4, v10
    v_subrev_u32 v18, 2048, v18
    v_add_u32 v8, 192, v1
    v_mul_u32_u24 v9, 7282, v8
    v_lshrrev_b32 v9, 16, v9
    v_mul_u32_u24 v10, 1008, v9
    v_lshl_add_u32 v19, v8, 4, v10
    v_subrev_u32 v19, 3072, v19
    v_add_u32 v8, 256, v1
    v_mul_u32_u24 v9, 7282, v8
    v_lshrrev_b32 v9, 16, v9
    v_mul_u32_u24 v10, 1008, v9
    v_lshl_add_u32 v20, v8, 4, v10
    v_add_u32 v8, 320, v1
    v_mul_u32_u24 v9, 7282, v8
    v_lshrrev_b32 v9, 16, v9
    v_mul_u32_u24 v10, 1008, v9
    v_lshl_add_u32 v21, v8, 4, v10
    v_subrev_u32 v21, 1024, v21
    v_add_u32 v8, 384, v1
    v_mul_u32_u24 v9, 7282, v8
    v_lshrrev_b32 v9, 16, v9
    v_mul_u32_u24 v10, 1008, v9
    v_lshl_add_u32 v22, v8, 4, v10
    v_subrev_u32 v22, 2048, v22
    v_add_u32 v8, 448, v1
    v_mul_u32_u24 v9, 7282, v8
    v_lshrrev_b32 v9, 16, v9
    v_mul_u32_u24 v10, 1008, v9
    v_lshl_add_u32 v23, v8, 4, v10
    v_subrev_u32 v23, 3072, v23
    v_add_u32 v8, 512, v1
    v_mul_u32_u24 v9, 7282, v8
    v_lshrrev_b32 v9, 16, v9
    v_mul_u32_u24 v10, 1008, v9
    v_lshl_add_u32 v24, v8, 4, v10
    s_mov_b32 s65, 20000
PL_DG:
    s_mov_b64 exec, 7
    buffer_load_dword v36, v15, s[16:19], 0 offen sc1
    s_waitcnt vmcnt(0)
    s_mov_b64 exec, 7
    v_cmp_ne_u32 s[66:67], s60, v36
    s_mov_b64 exec, -1
    s_cmp_eq_u64 s[66:67], 0
    s_cbranch_scc1 PD_DG
    s_sleep 4
    s_sub_u32 s65, s65, 1
    s_cmp_lg_u32 s65, 0
    s_cbranch_scc1 PL_DG
PD_DG:
    v_mov_b32 v31, 8
    s_waitcnt vmcnt(0)
    ds_write_b32 v2, v31 offset:8
    s_mul_i32 s28, s22, 20736
    v_lshlrev_b32 v8, 7, v1
    s_waitcnt lgkmcnt(0)
    buffer_load_dword v40, v8, s[12:15], s28 offen
    s_add_u32 s28, s28, 8192
    buffer_load_dword v41, v8, s[12:15], s28 offen
    s_add_u32 s28, s28, 4352
    buffer_load_dword v42, v8, s[12:15], s28 offen
    s_mov_b32 s65, 20000
PL_DC:
    buffer_load_dword v44, v14, s[16:19], 0 offen sc1
    buffer_load_dword v45, v15, s[16:19], 0 offen sc1
    s_waitcnt vmcnt(0)
    v_cmp_ne_u32 s[66:67], s60, v44
    v_cmp_ne_u32 s[68:69], s60, v45
    s_nop 0
    s_or_b64 s[66:67], s[66:67], s[68:69]
    s_cmp_eq_u64 s[66:67], 0
    s_cbranch_scc1 PD_DC
    s_sleep 8
    s_sub_u32 s65, s65, 1
    s_cmp_lg_u32 s65, 0
    s_cbranch_scc1 PL_DC
PD_DC:
    s_mul_i32 s40, s64, 144
    s_mul_i32 s41, s64, 294912
    s_lshl_b32 s42, s63, 7
    s_add_u32 s41, s41, s42
    s_add_u32 s41, s41, 8949760
    s_mov_b32 s65, 160000
LL_DW:
    ds_read_b32 v36, v37 offset:48
    s_waitcnt lgkmcnt(0)
    v_cmp_gt_u32 s[66:67], 2, v36
    s_nop 0
    s_cmp_eq_u64 s[66:67], 0
    s_cbranch_scc1 LD_DW
    s_sleep 8
    s_sub_u32 s65, s65, 1
    s_cmp_lg_u32 s65, 0
    s_cbranch_scc1 LL_DW
LD_DW:
    s_mov_b32 m0, 82944
    s_nop 0
    buffer_load_dwordx4 v30, s[16:19], s41 offen sc1 lds
    s_add_u32 s41, s41, 32768
    s_mov_b32 m0, 83968
    s_nop 0
    buffer_load_dwordx4 v30, s[16:19], s41 offen sc1 lds
    s_add_u32 s41, s41, 32768
    s_mov_b32 m0, 84992
    s_nop 0
    buffer_load_dwordx4 v30, s[16:19], s41 offen sc1 lds
    s_add_u32 s41, s41, 32768
    s_mov_b32 m0, 86016
    s_nop 0
    buffer_load_dwordx4 v30, s[16:19], s41 offen sc1 lds
    s_add_u32 s41, s41, 32768
    s_mov_b32 m0, 87040
    s_nop 0
    buffer_load_dwordx4 v30, s[16:19], s41 offen sc1 lds
    s_add_u32 s41, s41, 32768
    s_mov_b32 m0, 88064
    s_nop 0
    buffer_load_dwordx4 v30, s[16:19], s41 offen sc1 lds
    s_add_u32 s41, s41, 32768
    s_mov_b32 m0, 89088
    s_nop 0
    buffer_load_dwordx4 v30, s[16:19], s41 offen sc1 lds
    s_add_u32 s41, s41, 32768
    s_mov_b32 m0, 90112
    s_nop 0
    buffer_load_dwordx4 v30, s[16:19], s41 offen sc1 lds
    s_add_u32 s41, s41, 32768
    s_mov_b32 m0, 91136
    s_nop 0
    buffer_load_dwordx4 v30, s[16:19], s41 offen sc1 lds
    s_add_u32 s41, s41, 32768
    s_mov_b32 s42, 0
D_WO:
    s_add_u32 m0, s42, 0
    s_nop 0
    buffer_load_dwordx4 v16, s[12:15], s40 offen offset:0 lds
    buffer_load_dwordx4 v17, s[12:15], s40 offen offset:1024 lds
    buffer_load_dwordx4 v18, s[12:15], s40 offen offset:2048 lds
    buffer_load_dwordx4 v19, s[12:15], s40 offen offset:3072 lds
    s_add_u32 m0, s42, 4096
    s_nop 0
    buffer_load_dwordx4 v20, s[12:15], s40 offen offset:0 lds
    buffer_load_dwordx4 v21, s[12:15], s40 offen offset:1024 lds
    buffer_load_dwordx4 v22, s[12:15], s40 offen offset:2048 lds
    buffer_load_dwordx4 v23, s[12:15], s40 offen offset:3072 lds
    s_add_u32 m0, s42, 8192
    s_nop 0
    buffer_load_dwordx4 v24, s[12:15], s40 offen offset:0 lds
    s_add_u32 s40, s40, 73728
    s_add_u32 s42, s42, 9216
    s_waitcnt vmcnt(36)
    s_cmp_lt_u32 s42, 82944
    s_cbranch_scc1 D_WO
    s_waitcnt vmcnt(0)
    v_mov_b32 v31, 9
    ds_write_b32 v2, v31 offset:8
    s_endpgm
F_ATT:
    s_and_b32 s61, s22, 3
    s_lshl_b32 s63, s21, 2
    s_add_u32 s61, s61, s63
    s_lshr_b32 s62, s22, 2
    s_lshr_b32 s64, s22, 3
    s_add_u32 s63, s63, s64
    s_and_b32 s64, s22, 7
    s_sub_u32 s59, s20, 4
    s_cmp_lt_u32 s22, 28
    s_cselect_b32 s58, 0, 4
    s_xor_b32 s59, s59, s58
    s_and_b32 s58, s62, 0
    s_lshl_b32 s26, s62, 3
    s_add_u32 s26, s26, s59
    s_lshl_b32 s27, s61, 16
    s_lshl_b32 s28, s26, 10
    s_add_u32 s27, s27, s28
    s_lshr_b32 s29, s61, 1
    s_lshl_b32 s29, s29, 16
    s_add_u32 s28, s28, s29
    s_and_b32 s30, s61, 1
    s_lshl_b32 s30, s30, 2
    s_add_u32 s28, s28, s30
    s_add_u32 s28, s28, 13668352
    s_lshl_b32 s29, s26, 8
    s_add_u32 s29, s29, 15765508
    v_lshlrev_b32 v117, 3, v1
    v_and_b32 v122, 31, v1
    v_lshlrev_b32 v123, 3, v122
    v_lshrrev_b32 v124, 5, v1
    v_lshrrev_b32 v125, 4, v122
    v_xor_b32 v124, v124, v125
    v_lshlrev_b32 v124, 4, v124
    v_lshlrev_b32 v118, 5, v122
    v_add_u32 v118, 9216, v118
    v_and_b32 v126, 27, v122
    v_cmp_ne_u32 s[32:33], 18, v126
    v_cmp_gt_u32 s[34:35], 18, v122
    v_mov_b32 v126, 147520
    v_mov_b32 v127, 147552
    v_cndmask_b32 v126, v126, v127, s[32:33]
    v_mov_b32 v120, 18432
    v_cndmask_b32 v118, v126, v118, s[34:35]
    v_cndmask_b32 v120, 0, v120, s[34:35]
    v_add_u32 v118, v118, v124
    v_mov_b32 v116, 0xdddd
    v_mov_b32 v91, 0x3f803f80
    v_mov_b32 v89, 0
    v_lshlrev_b32 v119, 2, v1
    v_mov_b32 v128, 163584
    v_mov_b32 v126, 0
    s_cmp_lt_u32 s59, 4
    s_cselect_b64 vcc, -1, 0
    v_and_b32 v22, 3, v1
    v_lshl_add_u32 v22, v22, 2, v128
    s_lshl_b32 s43, s59, 2
    v_add_u32 v130, s43, v128
    v_lshrrev_b32 v20, 5, v1
    v_lshl_add_u32 v20, v20, 10, v123
    v_lshlrev_b32 v21, 4, v1
    s_mul_i32 s36, s61, 139264
    s_mul_i32 s37, s58, 17408
    s_add_u32 s36, s36, s37
    s_add_u32 s36, s36, 2097152
    s_lshl_b32 s38, s59, 11
    s_add_u32 s37, s36, s38
    s_lshl_b32 s40, s59, 8
    s_add_u32 s41, s36, s40
    s_add_u32 s41, s41, 16384
    s_lshr_b32 s42, s61, 1
    s_lshl_b32 s42, s42, 16
    s_add_u32 s42, s42, s30
    s_lshl_b32 s44, s58, 13
    s_add_u32 s42, s42, s44
    s_add_u32 s42, s42, s38
    s_add_u32 s42, s42, 14716928
    s_mul_i32 s54, s26, 36864
    s_lshl_b32 s53, s61, 10
    s_add_u32 s53, s53, s54
    s_add_u32 s53, s53, 11309056
    s_lshl_b32 s55, s61, 7
    s_add_u32 s54, s54, s55
    s_add_u32 s54, s54, 11341824
    s_lshl_b32 s55, s26, 1
    s_lshr_b32 s56, s61, 4
    s_add_u32 s55, s55, s56
    s_mul_i32 s55, s55, 256
    s_and_b32 s56, s61, 15
    s_lshl_b32 s56, s56, 2
    s_add_u32 s55, s55, s56
    s_add_u32 s55, s55, 15874048
    s_cmp_eq_u32 s58, 7
    s_cselect_b32 s44, -7, 1
    s_mul_i32 s45, s44, 17408
    s_lshl_b32 s46, s44, 13
    v_lshrrev_b32 v92, 2, v1
    v_mul_u32_u24 v92, 576, v92
    v_and_b32 v93, 3, v1
    v_lshl_add_u32 v92, v93, 4, v92
    v_cmp_gt_u32 s[70:71], 2, v93
    v_add_u32 v92, 147520, v92
    s_nop 0
    v_cndmask_b32 v96, 0, v91, s[70:71]
    v_mov_b32 v97, v96
    v_mov_b32 v98, v96
    v_mov_b32 v99, v96
    ds_write_b128 v92, v[96:99]
    v_mov_b32 v2, 0
    v_mov_b32 v3, 0
    v_mov_b32 v4, 0
    v_mov_b32 v5, 0
    v_mov_b32 v6, 0
    v_mov_b32 v7, 0
    v_mov_b32 v8, 0
    v_mov_b32 v9, 0
    v_mov_b32 v10, 0
    v_mov_b32 v11, 0
    v_mov_b32 v12, 0
    v_mov_b32 v13, 0
    v_mov_b32 v14, 0
    v_mov_b32 v15, 0
    v_mov_b32 v16, 0
    v_mov_b32 v17, 0
    v_mov_b32 v155, 0
    v_mov_b32 v150, 0
    v_mov_b32 v151, 0
    v_mov_b32 v154, 0
    v_mov_b32 v156, 0
    v_mov_b32 v157, 0
    v_mov_b32 v158, 0
    s_mov_b32 s48, s29
    s_mov_b32 s49, s29
    s_mov_b32 s50, s29
    s_mov_b32 s51, s29
    s_cbranch_vccz A_NS
    s_and_b32 s70, s59, 1
    s_lshr_b32 s47, s59, 1
    s_lshl_b32 s71, s63, 1
    s_add_u32 s71, s71, s70
    v_and_b32 v132, 15, v1
    v_lshrrev_b32 v133, 4, v1
    v_bfe_u32 v134, v1, 2, 2
    v_and_b32 v135, 3, v1
    s_mul_i32 s72, s47, 41472
    v_lshl_add_u32 v135, v135, 3, s72
    v_lshrrev_b32 v136, 5, v1
    v_mul_u32_u24 v136, 10, v136
    v_lshl_add_u32 v136, v133, 2, v136
    v_add_u32 v136, v136, v134
    v_mul_u32_u24 v136, 144, v136
    v_add_u32 v148, v135, v136
    v_lshrrev_b32 v136, 1, v134
    v_lshl_add_u32 v136, v133, 2, v136
    v_mul_u32_u24 v136, 18, v136
    v_and_b32 v137, 1, v134
    v_add3_u32 v136, v136, v137, 16
    v_mul_u32_u24 v136, 144, v136
    v_add_u32 v149, v135, v136
    v_lshlrev_b32 v136, 9, v133
    v_lshl_add_u32 v150, v132, 4, v136
    v_lshl_add_u32 v151, v132, 2, v136
    s_mul_i32 s72, s59, 9728
    s_add_u32 s72, s72, 92160
    v_mul_u32_u24 v152, 304, v132
    v_lshlrev_b32 v136, 4, v133
    v_add3_u32 v152, v152, v136, s72
    s_lshl_b32 s72, s70, 2
    v_add_u32 v136, s72, v133
    v_and_b32 v137, 7, v132
    v_xor_b32 v136, v136, v137
    v_lshlrev_b32 v136, 4, v136
    v_lshl_add_u32 v153, v132, 7, v136
    v_add_u32 v153, 82944, v153
    s_mul_i32 s48, s63, 73728
    s_mul_i32 s72, s64, 144
    s_add_u32 s48, s48, s72
    s_mul_i32 s72, s59, 18432
    s_add_u32 s48, s48, s72
    s_mul_i32 s49, s71, 36864
    s_add_u32 s49, s49, 11309056
    s_lshl_b32 s72, s47, 11
    s_add_u32 s50, s49, s72
    s_add_u32 s50, s50, 32768
    s_lshl_b32 s72, s47, 14
    s_add_u32 s49, s49, s72
    s_lshl_b32 s72, s71, 1
    s_add_u32 s72, s72, s47
    s_lshl_b32 s51, s72, 7
    s_add_u32 s51, s51, 15765504
    s_mul_i32 s72, s72, 256
    s_add_u32 s72, s72, 15874048
    v_lshl_add_u32 v154, v132, 2, s72
    v_lshlrev_b32 v155, 3, v132
    s_lshl_b32 s72, s47, 4
    v_add_u32 v136, s72, v132
    v_lshlrev_b32 v137, 3, v133
    v_sub_u32 v159, v136, v137
    v_add_u32 v136, 0, v1
    v_min_u32 v136, 143, v136
    v_mul_u32_u24 v137, 57, v136
    v_lshrrev_b32 v137, 9, v137
    v_lshl_add_u32 v156, v137, 16, v136
    v_add_u32 v136, 64, v1
    v_min_u32 v136, 143, v136
    v_mul_u32_u24 v137, 57, v136
    v_lshrrev_b32 v137, 9, v137
    v_lshl_add_u32 v157, v137, 16, v136
    v_add_u32 v136, 128, v1
    v_min_u32 v136, 143, v136
    v_mul_u32_u24 v137, 57, v136
    v_lshrrev_b32 v137, 9, v137
    v_lshl_add_u32 v158, v137, 16, v136
A_NS:
    s_setprio 0
    s_cmp_lg_u32 s59, 0
    s_cbranch_scc1 A_WGO
    s_mul_i32 s70, s61, 18
    s_and_b32 s71, s61, 1
    s_lshl_b32 s71, s71, 1
    s_sub_u32 s71, s70, s71
    s_and_b32 s72, s71, 127
    s_cmp_ge_u32 s72, 109
    s_cselect_b32 s72, 15, 3
    s_mov_b32 s73, 0
    s_add_u32 s74, s71, 576
    s_and_b32 s74, s74, 127
    s_cmp_ge_u32 s74, 109
    s_cselect_b32 s74, -1, 0xffff
    s_and_b32 s75, s70, 127
    s_cmp_ge_u32 s75, 111
    s_cselect_b32 s75, -1, 0xffff
    s_mul_i32 s76, s61, 512
    s_add_u32 s76, s76, 15782016
    v_lshl_add_u32 v30, v1, 2, s76
    s_lshl_b32 s77, s58, 1
    s_lshl_b32 s77, 15, s77
    s_lshl_b32 s78, s77, 16
    s_or_b32 s77, s77, s78
    s_and_b32 s74, s74, s77
    s_and_b32 s75, s75, s77
    s_lshl_b32 s77, s62, 3
    s_add_u32 s76, s76, s77
    s_sub_u32 s76, s76, 128
    v_bfe_u32 v28, v1, 1, 1
    v_lshlrev_b32 v28, 6, v28
    v_and_b32 v29, 1, v1
    v_lshl_add_u32 v28, v29, 2, v28
    v_add_u32 v31, s76, v28
    s_cmp_lt_u32 s22, 28
    s_cselect_b32 s70, 4, 2
    s_cselect_b32 s71, 0, 96
    v_add_u32 v32, s71, v128
    s_mov_b32 s65, 160000
LL_DF:
    ds_read_b32 v129, v32 offset:0
    s_waitcnt lgkmcnt(0)
    v_readfirstlane_b32 s66, v129
    s_nop 0
    s_cmp_ge_u32 s66, s70
    s_cbranch_scc1 LD_DF
    s_sleep 2
    s_sub_u32 s65, s65, 1
    s_cmp_lg_u32 s65, 0
    s_cbranch_scc1 LL_DF
LD_DF:
    s_mov_b32 s65, 20000
PL_GO:
    s_mov_b64 exec, s[74:75]
    v_mov_b32 v32, 0
    buffer_atomic_or v32, v30, s[16:19], 0 offen sc0 sc1
    s_mov_b64 exec, s[72:73]
    v_mov_b32 v33, 0
    buffer_atomic_or v33, v31, s[16:19], 0 offen sc0 sc1
    s_waitcnt vmcnt(0)
    s_mov_b64 exec, s[74:75]
    v_cmp_ne_u32 s[66:67], s60, v32
    s_mov_b64 exec, s[72:73]
    v_cmp_ne_u32 s[68:69], s60, v33
    s_mov_b64 exec, -1
    s_or_b64 s[66:67], s[66:67], s[68:69]
    s_cmp_eq_u64 s[66:67], 0
    s_cbranch_scc1 PD_GO
    s_sleep 1
    s_sub_u32 s65, s65, 1
    s_cmp_lg_u32 s65, 0
    s_cbranch_scc1 PL_GO
PD_GO:
    v_mov_b32 v129, 1
    s_mov_b64 exec, 1
    ds_write_b32 v128, v129 offset:4
    s_mov_b64 exec, -1
    s_branch A_GO
A_WGO:
    s_mov_b32 s65, 160000
LL_GO:
    ds_read_b32 v129, v128 offset:4
    s_waitcnt lgkmcnt(0)
    v_readfirstlane_b32 s66, v129
    s_nop 0
    s_cmp_ge_u32 s66, 1
    s_cbranch_scc1 LD_GO
    s_sleep 2
    s_sub_u32 s65, s65, 1
    s_cmp_lg_u32 s65, 0
    s_cbranch_scc1 LL_GO
LD_GO:
A_GO:
    buffer_load_dwordx2 v[84:85], v117, s[16:19], s27 offen sc1
    buffer_load_dwordx2 v[86:87], v117, s[16:19], s27 offen offset:512 sc1
    buffer_load_dword v88, v123, s[16:19], s28 offen sc1
    v_mov_b32 v121, v123
    s_setprio 1
    v_mov_b32 v131, v22
    s_cbranch_vccz A_P0
    s_setprio 2
    s_add_u32 m0, s38, 0
    s_add_u32 s43, s37, 8192
    buffer_load_dwordx4 v21, s[16:19], s37 offen sc1 lds
    buffer_load_dwordx4 v21, s[16:19], s37 offen offset:1024 sc1 lds
    s_add_u32 m0, s40, 8192
    s_add_u32 s37, s37, s45
    buffer_load_dword v20, s[16:19], s42 offen sc1 lds
    s_add_u32 m0, s38, 9216
    s_add_u32 s42, s42, s46
    buffer_load_dwordx4 v21, s[16:19], s43 offen sc1 lds
    buffer_load_dwordx4 v21, s[16:19], s43 offen offset:1024 sc1 lds
    s_add_u32 m0, s40, 17408
    s_nop 0
    buffer_load_dword v119, s[16:19], s41 offen sc1 lds
    s_add_u32 s41, s41, s45
    s_waitcnt vmcnt(0)
    v_mov_b32 v122, 1
    s_mov_b64 exec, 1
    ds_write_b32 v130, v122 offset:16
    s_mov_b64 exec, -1
    s_mov_b32 s65, 160000
LL_L1:
    ds_read_b32 v129, v131 offset:16
    s_waitcnt lgkmcnt(0)
    v_cmp_gt_u32 s[66:67], 1, v129
    s_nop 0
    s_cmp_eq_u64 s[66:67], 0
    s_cbranch_scc1 LD_L1
    s_sub_u32 s65, s65, 1
    s_cmp_lg_u32 s65, 0
    s_cbranch_scc1 LL_L1
LD_L1:
    ds_read2st64_b64 v[92:95], v117 offset0:0 offset1:1
    ds_read2st64_b64 v[96:99], v117 offset0:2 offset1:3
    ds_read_b32 v90, v119 offset:8192
    ds_read_b128 v[100:103], v118 offset:0
    ds_read_b128 v[104:107], v118 offset:576
    ds_read_b128 v[108:111], v118 offset:1152
    s_add_u32 m0, s38, 18432
    s_add_u32 s43, s37, 8192
    buffer_load_dwordx4 v21, s[16:19], s37 offen sc1 lds
    buffer_load_dwordx4 v21, s[16:19], s37 offen offset:1024 sc1 lds
    s_add_u32 m0, s40, 26624
    s_add_u32 s37, s37, s45
    buffer_load_dword v20, s[16:19], s42 offen sc1 lds
    s_add_u32 m0, s38, 27648
    s_add_u32 s42, s42, s46
    buffer_load_dwordx4 v21, s[16:19], s43 offen sc1 lds
    buffer_load_dwordx4 v21, s[16:19], s43 offen offset:1024 sc1 lds
    s_add_u32 m0, s40, 35840
    s_nop 0
    buffer_load_dword v119, s[16:19], s41 offen sc1 lds
    s_add_u32 s41, s41, s45
    s_branch A_P3
A_P0:
    s_waitcnt vmcnt(0)
    v_mov_b32 v122, 1
    s_mov_b64 exec, 1
    ds_write_b32 v130, v122 offset:48
    s_mov_b64 exec, -1
A_P2:
    s_mov_b32 s65, 160000
LL_L0:
    ds_read_b32 v129, v131 offset:16
    s_waitcnt lgkmcnt(0)
    v_cmp_gt_u32 s[66:67], 1, v129
    s_nop 0
    s_cmp_eq_u64 s[66:67], 0
    s_cbranch_scc1 LD_L0
    s_sleep 1
    s_sub_u32 s65, s65, 1
    s_cmp_lg_u32 s65, 0
    s_cbranch_scc1 LL_L0
LD_L0:
    ds_read2st64_b64 v[92:95], v117 offset0:0 offset1:1
    ds_read2st64_b64 v[96:99], v117 offset0:2 offset1:3
    ds_read_b32 v90, v119 offset:8192
    ds_read_b128 v[100:103], v118 offset:0
    ds_read_b128 v[104:107], v118 offset:576
    ds_read_b128 v[108:111], v118 offset:1152
A_P3:
    s_waitcnt lgkmcnt(5)
    v_mfma_f32_32x32x16_bf16 v[20:35], v[92:95], v[84:87], 0
    s_waitcnt lgkmcnt(4)
    v_mfma_f32_32x32x16_bf16 v[36:51], v[96:99], v[84:87], 0
    ds_read2st64_b64 v[92:95], v117 offset0:4 offset1:5
    ds_read2st64_b64 v[96:99], v117 offset0:6 offset1:7
    s_nop 7
    v_max3_f32 v122, v20, v21, v22
    v_max3_f32 v123, v23, v24, v25
    v_max3_f32 v122, v122, v26, v27
    v_max3_f32 v123, v123, v28, v29
    v_max3_f32 v122, v122, v30, v31
    v_max3_f32 v123, v123, v32, v33
    v_max3_f32 v122, v122, v34, v35
    v_max_f32 v122, v122, v123
    v_mov_b32 v123, v122
    s_nop 1
    v_permlane32_swap_b32 v122, v123
    v_max_f32 v122, v122, v123
    v_cvt_pk_bf16_f32 v123, -v122, -v122
    v_and_b32 v123, 0xffff0000, v123
    v_sub_f32 v124, -v122, v123
    v_cvt_pk_bf16_f32 v89, v123, v124
    s_waitcnt lgkmcnt(5)
    s_nop 0
    v_mfma_f32_32x32x4_2b_bf16 v[20:51], v[90:91], v[88:89], v[20:51]
    ds_read_b32 v90, v119 offset:8448
    s_nop 15
    s_nop 1
A_LP:
    s_waitcnt lgkmcnt(0)
    v_exp_f32 v20, v20
    v_exp_f32 v21, v21
    ds_read_b128 v[112:115], v118 offset:1728
    v_exp_f32 v22, v22
    v_exp_f32 v23, v23
    v_exp_f32 v24, v24
    v_exp_f32 v25, v25
    v_exp_f32 v26, v26
    v_exp_f32 v27, v27
    v_mfma_f32_32x32x4_2b_bf16 v[52:83], v[90:91], v[88:89], 0
    ds_read_b32 v90, v119 offset:8704
    v_exp_f32 v28, v28
    v_exp_f32 v29, v29
    v_exp_f32 v30, v30
    v_exp_f32 v31, v31
    v_exp_f32 v32, v32
    v_exp_f32 v33, v33
    v_exp_f32 v34, v34
    v_smfmac_f32_32x32x32_bf16 v[2:17], v[100:103], v[20:27], v116
    ds_read_b128 v[100:103], v118 offset:2304
    v_exp_f32 v35, v35
    v_exp_f32 v36, v36
    v_exp_f32 v37, v37
    v_smfmac_f32_32x32x32_bf16 v[2:17], v[104:107], v[28:35], v116
    ds_read_b128 v[104:107], v118 offset:2880
    v_exp_f32 v38, v38
    v_exp_f32 v39, v39
    v_exp_f32 v40, v40
    v_mfma_f32_32x32x16_bf16 v[52:67], v[92:95], v[84:87], v[52:67]
    ds_read2st64_b64 v[92:95], v117 offset0:8 offset1:9
    v_exp_f32 v41, v41
    v_exp_f32 v42, v42
    v_exp_f32 v43, v43
    v_exp_f32 v44, v44
    v_mfma_f32_32x32x16_bf16 v[68:83], v[96:99], v[84:87], v[68:83]
    ds_read2st64_b64 v[96:99], v117 offset0:10 offset1:11
    v_exp_f32 v45, v45
    v_exp_f32 v46, v46
    v_exp_f32 v47, v47
    v_smfmac_f32_32x32x32_bf16 v[2:17], v[108:111], v[36:43], v116
    ds_read_b128 v[108:111], v118 offset:3456
    v_exp_f32 v48, v48
    v_exp_f32 v49, v49
    v_exp_f32 v50, v50
    v_exp_f32 v51, v51
    s_waitcnt lgkmcnt(0)
    s_waitcnt vmcnt(0)
    v_mov_b32 v122, 1
    s_mov_b64 exec, 1
    ds_write_b32 v130, v122 offset:48
    s_mov_b64 exec, -1
    v_exp_f32 v52, v52
    v_exp_f32 v53, v53
    v_smfmac_f32_32x32x32_bf16 v[2:17], v[112:115], v[44:51], v116
    ds_read_b128 v[112:115], v118 offset:4032
    v_exp_f32 v54, v54
    v_exp_f32 v55, v55
    v_exp_f32 v56, v56
    v_exp_f32 v57, v57
    v_exp_f32 v58, v58
    v_exp_f32 v59, v59
    v_mfma_f32_32x32x4_2b_bf16 v[20:51], v[90:91], v[88:89], 0
    ds_read_b32 v90, v119 offset:8960
    v_exp_f32 v60, v60
    v_exp_f32 v61, v61
    v_exp_f32 v62, v62
    v_exp_f32 v63, v63
    v_exp_f32 v64, v64
    v_exp_f32 v65, v65
    v_exp_f32 v66, v66
    v_smfmac_f32_32x32x32_bf16 v[2:17], v[100:103], v[52:59], v116
    ds_read_b128 v[100:103], v118 offset:4608
    v_exp_f32 v67, v67
    v_exp_f32 v68, v68
    v_exp_f32 v69, v69
    v_smfmac_f32_32x32x32_bf16 v[2:17], v[104:107], v[60:67], v116
    ds_read_b128 v[104:107], v118 offset:5184
    v_exp_f32 v70, v70
    v_exp_f32 v71, v71
    v_exp_f32 v72, v72
    v_mfma_f32_32x32x16_bf16 v[20:35], v[92:95], v[84:87], v[20:35]
    ds_read2st64_b64 v[92:95], v117 offset0:12 offset1:13
    v_exp_f32 v73, v73
    v_exp_f32 v74, v74
    v_exp_f32 v75, v75
    v_exp_f32 v76, v76
    v_mfma_f32_32x32x16_bf16 v[36:51], v[96:99], v[84:87], v[36:51]
    ds_read2st64_b64 v[96:99], v117 offset0:14 offset1:15
    v_exp_f32 v77, v77
    v_exp_f32 v78, v78
    v_exp_f32 v79, v79
    v_smfmac_f32_32x32x32_bf16 v[2:17], v[108:111], v[68:75], v116
    ds_read_b128 v[108:111], v118 offset:5760
    ds_read_b32 v129, v131 offset:48
    v_exp_f32 v80, v80
    v_exp_f32 v81, v81
    v_exp_f32 v82, v82
    v_exp_f32 v83, v83
    s_waitcnt lgkmcnt(0)
    v_cmp_gt_u32 s[66:67], 1, v129
    v_exp_f32 v20, v20
    v_exp_f32 v21, v21
    s_cmp_eq_u64 s[66:67], 0
    s_cbranch_scc0 A_W2
A_R2:
    v_smfmac_f32_32x32x32_bf16 v[2:17], v[112:115], v[76:83], v116
    ds_read_b128 v[112:115], v118 offset:6336
    v_exp_f32 v22, v22
    v_exp_f32 v23, v23
    v_exp_f32 v24, v24
    v_exp_f32 v25, v25
    v_exp_f32 v26, v26
    v_exp_f32 v27, v27
    v_mfma_f32_32x32x4_2b_bf16 v[52:83], v[90:91], v[88:89], 0
    ds_read_b32 v90, v119 offset:26624
    v_exp_f32 v28, v28
    v_exp_f32 v29, v29
    v_exp_f32 v30, v30
    v_exp_f32 v31, v31
    v_exp_f32 v32, v32
    v_exp_f32 v33, v33
    v_exp_f32 v34, v34
    v_smfmac_f32_32x32x32_bf16 v[2:17], v[100:103], v[20:27], v116
    ds_read_b128 v[100:103], v118 offset:6912
    v_exp_f32 v35, v35
    v_exp_f32 v36, v36
    v_exp_f32 v37, v37
    v_smfmac_f32_32x32x32_bf16 v[2:17], v[104:107], v[28:35], v116
    ds_read_b128 v[104:107], v118 offset:7488
    v_exp_f32 v38, v38
    v_exp_f32 v39, v39
    v_exp_f32 v40, v40
    v_mfma_f32_32x32x16_bf16 v[52:67], v[92:95], v[84:87], v[52:67]
    ds_read2st64_b64 v[92:95], v117 offset0:36 offset1:37
    v_exp_f32 v41, v41
    v_exp_f32 v42, v42
    v_exp_f32 v43, v43
    v_exp_f32 v44, v44
    v_mfma_f32_32x32x16_bf16 v[68:83], v[96:99], v[84:87], v[68:83]
    ds_read2st64_b64 v[96:99], v117 offset0:38 offset1:39
    v_exp_f32 v45, v45
    v_exp_f32 v46, v46
    v_exp_f32 v47, v47
    v_smfmac_f32_32x32x32_bf16 v[2:17], v[108:111], v[36:43], v116
    ds_read_b128 v[108:111], v118 offset:8064
    v_exp_f32 v48, v48
    v_exp_f32 v49, v49
    v_exp_f32 v50, v50
    v_exp_f32 v51, v51
    s_waitcnt lgkmcnt(0)
    v_exp_f32 v52, v52
    v_exp_f32 v53, v53
    v_smfmac_f32_32x32x32_bf16 v[2:17], v[112:115], v[44:51], v116
    ds_read_b128 v[112:115], v118 offset:8640
    v_exp_f32 v54, v54
    v_exp_f32 v55, v55
    v_exp_f32 v56, v56
    v_exp_f32 v57, v57
    v_exp_f32 v58, v58
    v_exp_f32 v59, v59
    v_mfma_f32_32x32x4_2b_bf16 v[20:51], v[90:91], v[88:89], 0
    ds_read_b32 v90, v119 offset:26880
    v_exp_f32 v60, v60
    v_exp_f32 v61, v61
    v_exp_f32 v62, v62
    v_exp_f32 v63, v63
    v_exp_f32 v64, v64
    v_exp_f32 v65, v65
    v_exp_f32 v66, v66
    v_smfmac_f32_32x32x32_bf16 v[2:17], v[100:103], v[52:59], v116
    v_add_u32 v118, v120, v118
    ds_read_b128 v[100:103], v118 offset:0
    v_exp_f32 v67, v67
    v_exp_f32 v68, v68
    v_exp_f32 v69, v69
    v_smfmac_f32_32x32x32_bf16 v[2:17], v[104:107], v[60:67], v116
    ds_read_b128 v[104:107], v118 offset:576
    v_exp_f32 v70, v70
    v_exp_f32 v71, v71
    v_exp_f32 v72, v72
    v_mfma_f32_32x32x16_bf16 v[20:35], v[92:95], v[84:87], v[20:35]
    ds_read2st64_b64 v[92:95], v117 offset0:40 offset1:41
    v_exp_f32 v73, v73
    v_exp_f32 v74, v74
    v_exp_f32 v75, v75
    v_exp_f32 v76, v76
    v_mfma_f32_32x32x16_bf16 v[36:51], v[96:99], v[84:87], v[36:51]
    ds_read2st64_b64 v[96:99], v117 offset0:42 offset1:43
    v_exp_f32 v77, v77
    v_exp_f32 v78, v78
    v_exp_f32 v79, v79
    v_smfmac_f32_32x32x32_bf16 v[2:17], v[108:111], v[68:75], v116
    ds_read_b128 v[108:111], v118 offset:1152
    v_exp_f32 v80, v80
    v_exp_f32 v81, v81
    v_exp_f32 v82, v82
    v_exp_f32 v83, v83
    s_waitcnt lgkmcnt(0)
    v_exp_f32 v20, v20
    v_exp_f32 v21, v21
    v_smfmac_f32_32x32x32_bf16 v[2:17], v[112:115], v[76:83], v116
    ds_read_b128 v[112:115], v118 offset:1728
    v_exp_f32 v22, v22
    v_exp_f32 v23, v23
    v_exp_f32 v24, v24
    v_exp_f32 v25, v25
    v_exp_f32 v26, v26
    v_exp_f32 v27, v27
    v_mfma_f32_32x32x4_2b_bf16 v[52:83], v[90:91], v[88:89], 0
    ds_read_b32 v90, v119 offset:27136
    v_exp_f32 v28, v28
    v_exp_f32 v29, v29
    v_exp_f32 v30, v30
    v_exp_f32 v31, v31
    v_exp_f32 v32, v32
    v_exp_f32 v33, v33
    v_exp_f32 v34, v34
    v_smfmac_f32_32x32x32_bf16 v[2:17], v[100:103], v[20:27], v116
    ds_read_b128 v[100:103], v118 offset:2304
    v_exp_f32 v35, v35
    v_exp_f32 v36, v36
    v_exp_f32 v37, v37
    v_smfmac_f32_32x32x32_bf16 v[2:17], v[104:107], v[28:35], v116
    ds_read_b128 v[104:107], v118 offset:2880
    v_exp_f32 v38, v38
    v_exp_f32 v39, v39
    v_exp_f32 v40, v40
    v_mfma_f32_32x32x16_bf16 v[52:67], v[92:95], v[84:87], v[52:67]
    ds_read2st64_b64 v[92:95], v117 offset0:44 offset1:45
    v_exp_f32 v41, v41
    v_exp_f32 v42, v42
    v_exp_f32 v43, v43
    v_exp_f32 v44, v44
    v_mfma_f32_32x32x16_bf16 v[68:83], v[96:99], v[84:87], v[68:83]
    ds_read2st64_b64 v[96:99], v117 offset0:46 offset1:47
    v_exp_f32 v45, v45
    v_exp_f32 v46, v46
    v_exp_f32 v47, v47
    v_smfmac_f32_32x32x32_bf16 v[2:17], v[108:111], v[36:43], v116
    ds_read_b128 v[108:111], v118 offset:3456
    v_exp_f32 v48, v48
    v_exp_f32 v49, v49
    v_exp_f32 v50, v50
    v_exp_f32 v51, v51
    s_waitcnt lgkmcnt(0)
    v_exp_f32 v52, v52
    v_exp_f32 v53, v53
    v_smfmac_f32_32x32x32_bf16 v[2:17], v[112:115], v[44:51], v116
    ds_read_b128 v[112:115], v118 offset:4032
    v_exp_f32 v54, v54
    v_exp_f32 v55, v55
    v_exp_f32 v56, v56
    v_exp_f32 v57, v57
    v_exp_f32 v58, v58
    v_exp_f32 v59, v59
    v_mfma_f32_32x32x4_2b_bf16 v[20:51], v[90:91], v[88:89], 0
    ds_read_b32 v90, v119 offset:27392
    v_exp_f32 v60, v60
    v_exp_f32 v61, v61
    v_exp_f32 v62, v62
    v_exp_f32 v63, v63
    v_exp_f32 v64, v64
    v_exp_f32 v65, v65
    v_exp_f32 v66, v66
    v_smfmac_f32_32x32x32_bf16 v[2:17], v[100:103], v[52:59], v116
    ds_read_b128 v[100:103], v118 offset:4608
    v_exp_f32 v67, v67
    v_exp_f32 v68, v68
    v_exp_f32 v69, v69
    v_smfmac_f32_32x32x32_bf16 v[2:17], v[104:107], v[60:67], v116
    ds_read_b128 v[104:107], v118 offset:5184
    v_exp_f32 v70, v70
    v_exp_f32 v71, v71
    v_exp_f32 v72, v72
    v_mfma_f32_32x32x16_bf16 v[20:35], v[92:95], v[84:87], v[20:35]
    ds_read2st64_b64 v[92:95], v117 offset0:48 offset1:49
    v_exp_f32 v73, v73
    v_exp_f32 v74, v74
    v_exp_f32 v75, v75
    v_exp_f32 v76, v76
    v_mfma_f32_32x32x16_bf16 v[36:51], v[96:99], v[84:87], v[36:51]
    ds_read2st64_b64 v[96:99], v117 offset0:50 offset1:51
    v_exp_f32 v77, v77
    v_exp_f32 v78, v78
    v_exp_f32 v79, v79
    v_smfmac_f32_32x32x32_bf16 v[2:17], v[108:111], v[68:75], v116
    ds_read_b128 v[108:111], v118 offset:5760
    ds_read_b32 v129, v128 offset:8
    v_exp_f32 v80, v80
    v_exp_f32 v81, v81
    v_exp_f32 v82, v82
    v_exp_f32 v83, v83
    s_waitcnt lgkmcnt(0)
    v_readfirstlane_b32 s66, v129
    v_exp_f32 v20, v20
    v_exp_f32 v21, v21
    s_cmp_ge_u32 s66, 3
    s_cbranch_scc0 A_W6
A_R6:
    v_smfmac_f32_32x32x32_bf16 v[2:17], v[112:115], v[76:83], v116
    ds_read_b128 v[112:115], v118 offset:6336
    v_exp_f32 v22, v22
    v_exp_f32 v23, v23
    v_exp_f32 v24, v24
    v_exp_f32 v25, v25
    v_exp_f32 v26, v26
    v_exp_f32 v27, v27
    v_mfma_f32_32x32x4_2b_bf16 v[52:83], v[90:91], v[88:89], 0
    ds_read_b32 v90, v119 offset:45056
    v_exp_f32 v28, v28
    v_exp_f32 v29, v29
    v_exp_f32 v30, v30
    v_exp_f32 v31, v31
    v_exp_f32 v32, v32
    v_exp_f32 v33, v33
    v_exp_f32 v34, v34
    v_smfmac_f32_32x32x32_bf16 v[2:17], v[100:103], v[20:27], v116
    ds_read_b128 v[100:103], v118 offset:6912
    v_exp_f32 v35, v35
    v_exp_f32 v36, v36
    v_exp_f32 v37, v37
    v_smfmac_f32_32x32x32_bf16 v[2:17], v[104:107], v[28:35], v116
    ds_read_b128 v[104:107], v118 offset:7488
    v_exp_f32 v38, v38
    v_exp_f32 v39, v39
    v_exp_f32 v40, v40
    v_mfma_f32_32x32x16_bf16 v[52:67], v[92:95], v[84:87], v[52:67]
    ds_read2st64_b64 v[92:95], v117 offset0:72 offset1:73
    v_exp_f32 v41, v41
    v_exp_f32 v42, v42
    v_exp_f32 v43, v43
    v_exp_f32 v44, v44
    v_mfma_f32_32x32x16_bf16 v[68:83], v[96:99], v[84:87], v[68:83]
    ds_read2st64_b64 v[96:99], v117 offset0:74 offset1:75
    v_exp_f32 v45, v45
    v_exp_f32 v46, v46
    v_exp_f32 v47, v47
    v_smfmac_f32_32x32x32_bf16 v[2:17], v[108:111], v[36:43], v116
    ds_read_b128 v[108:111], v118 offset:8064
    v_exp_f32 v48, v48
    v_exp_f32 v49, v49
    v_exp_f32 v50, v50
    v_exp_f32 v51, v51
    s_waitcnt lgkmcnt(0)
    v_exp_f32 v52, v52
    v_exp_f32 v53, v53
    v_smfmac_f32_32x32x32_bf16 v[2:17], v[112:115], v[44:51], v116
    ds_read_b128 v[112:115], v118 offset:8640
    v_exp_f32 v54, v54
    v_exp_f32 v55, v55
    v_exp_f32 v56, v56
    v_exp_f32 v57, v57
    v_exp_f32 v58, v58
    v_exp_f32 v59, v59
    v_mfma_f32_32x32x4_2b_bf16 v[20:51], v[90:91], v[88:89], 0
    ds_read_b32 v90, v119 offset:45312
    v_exp_f32 v60, v60
    v_exp_f32 v61, v61
    v_exp_f32 v62, v62
    v_exp_f32 v63, v63
    v_exp_f32 v64, v64
    v_exp_f32 v65, v65
    v_exp_f32 v66, v66
    v_smfmac_f32_32x32x32_bf16 v[2:17], v[100:103], v[52:59], v116
    v_add_u32 v118, v120, v118
    ds_read_b128 v[100:103], v118 offset:0
    v_exp_f32 v67, v67
    v_exp_f32 v68, v68
    v_exp_f32 v69, v69
    v_smfmac_f32_32x32x32_bf16 v[2:17], v[104:107], v[60:67], v116
    ds_read_b128 v[104:107], v118 offset:576
    v_exp_f32 v70, v70
    v_exp_f32 v71, v71
    v_exp_f32 v72, v72
    v_mfma_f32_32x32x16_bf16 v[20:35], v[92:95], v[84:87], v[20:35]
    ds_read2st64_b64 v[92:95], v117 offset0:76 offset1:77
    v_exp_f32 v73, v73
    v_exp_f32 v74, v74
    v_exp_f32 v75, v75
    v_exp_f32 v76, v76
    v_mfma_f32_32x32x16_bf16 v[36:51], v[96:99], v[84:87], v[36:51]
    ds_read2st64_b64 v[96:99], v117 offset0:78 offset1:79
    v_exp_f32 v77, v77
    v_exp_f32 v78, v78
    v_exp_f32 v79, v79
    v_smfmac_f32_32x32x32_bf16 v[2:17], v[108:111], v[68:75], v116
    ds_read_b128 v[108:111], v118 offset:1152
    v_exp_f32 v80, v80
    v_exp_f32 v81, v81
    v_exp_f32 v82, v82
    v_exp_f32 v83, v83
    s_waitcnt lgkmcnt(0)
    v_exp_f32 v20, v20
    v_exp_f32 v21, v21
    v_smfmac_f32_32x32x32_bf16 v[2:17], v[112:115], v[76:83], v116
    ds_read_b128 v[112:115], v118 offset:1728
    v_exp_f32 v22, v22
    v_exp_f32 v23, v23
    v_exp_f32 v24, v24
    v_exp_f32 v25, v25
    v_exp_f32 v26, v26
    v_exp_f32 v27, v27
    v_mfma_f32_32x32x4_2b_bf16 v[52:83], v[90:91], v[88:89], 0
    ds_read_b32 v90, v119 offset:45568
    v_exp_f32 v28, v28
    v_exp_f32 v29, v29
    v_exp_f32 v30, v30
    v_exp_f32 v31, v31
    v_exp_f32 v32, v32
    v_exp_f32 v33, v33
    v_exp_f32 v34, v34
    v_smfmac_f32_32x32x32_bf16 v[2:17], v[100:103], v[20:27], v116
    ds_read_b128 v[100:103], v118 offset:2304
    v_exp_f32 v35, v35
    v_exp_f32 v36, v36
    v_exp_f32 v37, v37
    v_smfmac_f32_32x32x32_bf16 v[2:17], v[104:107], v[28:35], v116
    ds_read_b128 v[104:107], v118 offset:2880
    v_exp_f32 v38, v38
    v_exp_f32 v39, v39
    v_exp_f32 v40, v40
    v_mfma_f32_32x32x16_bf16 v[52:67], v[92:95], v[84:87], v[52:67]
    ds_read2st64_b64 v[92:95], v117 offset0:80 offset1:81
    v_exp_f32 v41, v41
    v_exp_f32 v42, v42
    v_exp_f32 v43, v43
    v_exp_f32 v44, v44
    v_mfma_f32_32x32x16_bf16 v[68:83], v[96:99], v[84:87], v[68:83]
    ds_read2st64_b64 v[96:99], v117 offset0:82 offset1:83
    v_exp_f32 v45, v45
    v_exp_f32 v46, v46
    v_exp_f32 v47, v47
    v_smfmac_f32_32x32x32_bf16 v[2:17], v[108:111], v[36:43], v116
    ds_read_b128 v[108:111], v118 offset:3456
    v_exp_f32 v48, v48
    v_exp_f32 v49, v49
    v_exp_f32 v50, v50
    v_exp_f32 v51, v51
    s_waitcnt lgkmcnt(0)
    v_exp_f32 v52, v52
    v_exp_f32 v53, v53
    v_smfmac_f32_32x32x32_bf16 v[2:17], v[112:115], v[44:51], v116
    ds_read_b128 v[112:115], v118 offset:4032
    v_exp_f32 v54, v54
    v_exp_f32 v55, v55
    v_exp_f32 v56, v56
    v_exp_f32 v57, v57
    v_exp_f32 v58, v58
    v_exp_f32 v59, v59
    v_mfma_f32_32x32x4_2b_bf16 v[20:51], v[90:91], v[88:89], 0
    ds_read_b32 v90, v119 offset:45824
    v_exp_f32 v60, v60
    v_exp_f32 v61, v61
    v_exp_f32 v62, v62
    v_exp_f32 v63, v63
    v_exp_f32 v64, v64
    v_exp_f32 v65, v65
    v_exp_f32 v66, v66
    v_smfmac_f32_32x32x32_bf16 v[2:17], v[100:103], v[52:59], v116
    ds_read_b128 v[100:103], v118 offset:4608
    v_exp_f32 v67, v67
    v_exp_f32 v68, v68
    v_exp_f32 v69, v69
    v_smfmac_f32_32x32x32_bf16 v[2:17], v[104:107], v[60:67], v116
    ds_read_b128 v[104:107], v118 offset:5184
    v_exp_f32 v70, v70
    v_exp_f32 v71, v71
    v_exp_f32 v72, v72
    v_mfma_f32_32x32x16_bf16 v[20:35], v[92:95], v[84:87], v[20:35]
    ds_read2st64_b64 v[92:95], v117 offset0:84 offset1:85
    v_exp_f32 v73, v73
    v_exp_f32 v74, v74
    v_exp_f32 v75, v75
    v_exp_f32 v76, v76
    v_mfma_f32_32x32x16_bf16 v[36:51], v[96:99], v[84:87], v[36:51]
    ds_read2st64_b64 v[96:99], v117 offset0:86 offset1:87
    v_exp_f32 v77, v77
    v_exp_f32 v78, v78
    v_exp_f32 v79, v79
    v_smfmac_f32_32x32x32_bf16 v[2:17], v[108:111], v[68:75], v116
    ds_read_b128 v[108:111], v118 offset:5760
    ds_read_b32 v129, v128 offset:8
    v_exp_f32 v80, v80
    v_exp_f32 v81, v81
    v_exp_f32 v82, v82
    v_exp_f32 v83, v83
    s_waitcnt lgkmcnt(0)
    v_readfirstlane_b32 s66, v129
    v_exp_f32 v20, v20
    v_exp_f32 v21, v21
    s_cmp_ge_u32 s66, 5
    s_cbranch_scc0 A_W10
A_R10:
    v_smfmac_f32_32x32x32_bf16 v[2:17], v[112:115], v[76:83], v116
    ds_read_b128 v[112:115], v118 offset:6336
    v_exp_f32 v22, v22
    v_exp_f32 v23, v23
    v_exp_f32 v24, v24
    v_exp_f32 v25, v25
    v_exp_f32 v26, v26
    v_exp_f32 v27, v27
    v_mfma_f32_32x32x4_2b_bf16 v[52:83], v[90:91], v[88:89], 0
    ds_read_b32 v90, v119 offset:63488
    v_exp_f32 v28, v28
    v_exp_f32 v29, v29
    v_exp_f32 v30, v30
    v_exp_f32 v31, v31
    v_exp_f32 v32, v32
    v_exp_f32 v33, v33
    v_exp_f32 v34, v34
    v_smfmac_f32_32x32x32_bf16 v[2:17], v[100:103], v[20:27], v116
    ds_read_b128 v[100:103], v118 offset:6912
    v_exp_f32 v35, v35
    v_exp_f32 v36, v36
    v_exp_f32 v37, v37
    v_smfmac_f32_32x32x32_bf16 v[2:17], v[104:107], v[28:35], v116
    ds_read_b128 v[104:107], v118 offset:7488
    v_exp_f32 v38, v38
    v_exp_f32 v39, v39
    v_exp_f32 v40, v40
    v_mfma_f32_32x32x16_bf16 v[52:67], v[92:95], v[84:87], v[52:67]
    ds_read2st64_b64 v[92:95], v117 offset0:108 offset1:109
    v_exp_f32 v41, v41
    v_exp_f32 v42, v42
    v_exp_f32 v43, v43
    v_exp_f32 v44, v44
    v_mfma_f32_32x32x16_bf16 v[68:83], v[96:99], v[84:87], v[68:83]
    ds_read2st64_b64 v[96:99], v117 offset0:110 offset1:111
    v_exp_f32 v45, v45
    v_exp_f32 v46, v46
    v_exp_f32 v47, v47
    v_smfmac_f32_32x32x32_bf16 v[2:17], v[108:111], v[36:43], v116
    ds_read_b128 v[108:111], v118 offset:8064
    v_exp_f32 v48, v48
    v_exp_f32 v49, v49
    v_exp_f32 v50, v50
    v_exp_f32 v51, v51
    s_waitcnt lgkmcnt(0)
    v_exp_f32 v52, v52
    v_exp_f32 v53, v53
    v_smfmac_f32_32x32x32_bf16 v[2:17], v[112:115], v[44:51], v116
    ds_read_b128 v[112:115], v118 offset:8640
    v_exp_f32 v54, v54
    v_exp_f32 v55, v55
    v_exp_f32 v56, v56
    v_exp_f32 v57, v57
    v_exp_f32 v58, v58
    v_exp_f32 v59, v59
    v_mfma_f32_32x32x4_2b_bf16 v[20:51], v[90:91], v[88:89], 0
    ds_read_b32 v90, v119 offset:63744
    v_exp_f32 v60, v60
    v_exp_f32 v61, v61
    v_exp_f32 v62, v62
    v_exp_f32 v63, v63
    v_exp_f32 v64, v64
    v_exp_f32 v65, v65
    v_exp_f32 v66, v66
    v_smfmac_f32_32x32x32_bf16 v[2:17], v[100:103], v[52:59], v116
    v_add_u32 v118, v120, v118
    ds_read_b128 v[100:103], v118 offset:0
    v_exp_f32 v67, v67
    v_exp_f32 v68, v68
    v_exp_f32 v69, v69
    v_smfmac_f32_32x32x32_bf16 v[2:17], v[104:107], v[60:67], v116
    ds_read_b128 v[104:107], v118 offset:576
    v_exp_f32 v70, v70
    v_exp_f32 v71, v71
    v_exp_f32 v72, v72
    v_mfma_f32_32x32x16_bf16 v[20:35], v[92:95], v[84:87], v[20:35]
    ds_read2st64_b64 v[92:95], v117 offset0:112 offset1:113
    v_exp_f32 v73, v73
    v_exp_f32 v74, v74
    v_exp_f32 v75, v75
    v_exp_f32 v76, v76
    v_mfma_f32_32x32x16_bf16 v[36:51], v[96:99], v[84:87], v[36:51]
    ds_read2st64_b64 v[96:99], v117 offset0:114 offset1:115
    v_exp_f32 v77, v77
    v_exp_f32 v78, v78
    v_exp_f32 v79, v79
    v_smfmac_f32_32x32x32_bf16 v[2:17], v[108:111], v[68:75], v116
    ds_read_b128 v[108:111], v118 offset:1152
    v_exp_f32 v80, v80
    v_exp_f32 v81, v81
    v_exp_f32 v82, v82
    v_exp_f32 v83, v83
    s_waitcnt lgkmcnt(0)
    v_exp_f32 v20, v20
    v_exp_f32 v21, v21
    v_smfmac_f32_32x32x32_bf16 v[2:17], v[112:115], v[76:83], v116
    ds_read_b128 v[112:115], v118 offset:1728
    v_exp_f32 v22, v22
    v_exp_f32 v23, v23
    v_exp_f32 v24, v24
    v_exp_f32 v25, v25
    v_exp_f32 v26, v26
    v_exp_f32 v27, v27
    v_mfma_f32_32x32x4_2b_bf16 v[52:83], v[90:91], v[88:89], 0
    ds_read_b32 v90, v119 offset:64000
    v_exp_f32 v28, v28
    v_exp_f32 v29, v29
    v_exp_f32 v30, v30
    v_exp_f32 v31, v31
    v_exp_f32 v32, v32
    v_exp_f32 v33, v33
    v_exp_f32 v34, v34
    v_smfmac_f32_32x32x32_bf16 v[2:17], v[100:103], v[20:27], v116
    ds_read_b128 v[100:103], v118 offset:2304
    v_exp_f32 v35, v35
    v_exp_f32 v36, v36
    v_exp_f32 v37, v37
    v_smfmac_f32_32x32x32_bf16 v[2:17], v[104:107], v[28:35], v116
    ds_read_b128 v[104:107], v118 offset:2880
    v_exp_f32 v38, v38
    v_exp_f32 v39, v39
    v_exp_f32 v40, v40
    v_mfma_f32_32x32x16_bf16 v[52:67], v[92:95], v[84:87], v[52:67]
    ds_read2st64_b64 v[92:95], v117 offset0:116 offset1:117
    v_exp_f32 v41, v41
    v_exp_f32 v42, v42
    v_exp_f32 v43, v43
    v_exp_f32 v44, v44
    v_mfma_f32_32x32x16_bf16 v[68:83], v[96:99], v[84:87], v[68:83]
    ds_read2st64_b64 v[96:99], v117 offset0:118 offset1:119
    v_exp_f32 v45, v45
    v_exp_f32 v46, v46
    v_exp_f32 v47, v47
    v_smfmac_f32_32x32x32_bf16 v[2:17], v[108:111], v[36:43], v116
    ds_read_b128 v[108:111], v118 offset:3456
    v_exp_f32 v48, v48
    v_exp_f32 v49, v49
    v_exp_f32 v50, v50
    v_exp_f32 v51, v51
    s_waitcnt lgkmcnt(0)
    v_exp_f32 v52, v52
    v_exp_f32 v53, v53
    v_smfmac_f32_32x32x32_bf16 v[2:17], v[112:115], v[44:51], v116
    ds_read_b128 v[112:115], v118 offset:4032
    v_exp_f32 v54, v54
    v_exp_f32 v55, v55
    v_exp_f32 v56, v56
    v_exp_f32 v57, v57
    v_exp_f32 v58, v58
    v_exp_f32 v59, v59
    v_mfma_f32_32x32x4_2b_bf16 v[20:51], v[90:91], v[88:89], 0
    ds_read_b32 v90, v119 offset:64256
    v_exp_f32 v60, v60
    v_exp_f32 v61, v61
    v_exp_f32 v62, v62
    v_exp_f32 v63, v63
    v_exp_f32 v64, v64
    v_exp_f32 v65, v65
    v_exp_f32 v66, v66
    v_smfmac_f32_32x32x32_bf16 v[2:17], v[100:103], v[52:59], v116
    ds_read_b128 v[100:103], v118 offset:4608
    v_exp_f32 v67, v67
    v_exp_f32 v68, v68
    v_exp_f32 v69, v69
    v_smfmac_f32_32x32x32_bf16 v[2:17], v[104:107], v[60:67], v116
    ds_read_b128 v[104:107], v118 offset:5184
    v_exp_f32 v70, v70
    v_exp_f32 v71, v71
    v_exp_f32 v72, v72
    v_mfma_f32_32x32x16_bf16 v[20:35], v[92:95], v[84:87], v[20:35]
    ds_read2st64_b64 v[92:95], v117 offset0:120 offset1:121
    v_exp_f32 v73, v73
    v_exp_f32 v74, v74
    v_exp_f32 v75, v75
    v_exp_f32 v76, v76
    v_mfma_f32_32x32x16_bf16 v[36:51], v[96:99], v[84:87], v[36:51]
    ds_read2st64_b64 v[96:99], v117 offset0:122 offset1:123
    v_exp_f32 v77, v77
    v_exp_f32 v78, v78
    v_exp_f32 v79, v79
    v_smfmac_f32_32x32x32_bf16 v[2:17], v[108:111], v[68:75], v116
    ds_read_b128 v[108:111], v118 offset:5760
    v_exp_f32 v80, v80
    v_exp_f32 v81, v81
    v_exp_f32 v82, v82
    v_exp_f32 v83, v83
    s_waitcnt lgkmcnt(0)
    v_exp_f32 v20, v20
    v_exp_f32 v21, v21
    v_smfmac_f32_32x32x32_bf16 v[2:17], v[112:115], v[76:83], v116
    ds_read_b128 v[112:115], v118 offset:6336
    v_add_u32 v119, 55296, v119
    v_exp_f32 v22, v22
    v_exp_f32 v23, v23
    v_exp_f32 v24, v24
    v_exp_f32 v25, v25
    v_exp_f32 v26, v26
    v_exp_f32 v27, v27
    v_mfma_f32_32x32x4_2b_bf16 v[52:83], v[90:91], v[88:89], 0
    ds_read_b32 v90, v119 offset:26624
    v_exp_f32 v28, v28
    v_exp_f32 v29, v29
    v_exp_f32 v30, v30
    v_exp_f32 v31, v31
    v_exp_f32 v32, v32
    v_exp_f32 v33, v33
    v_exp_f32 v34, v34
    v_smfmac_f32_32x32x32_bf16 v[2:17], v[100:103], v[20:27], v116
    ds_read_b128 v[100:103], v118 offset:6912
    v_exp_f32 v35, v35
    v_exp_f32 v36, v36
    v_exp_f32 v37, v37
    v_smfmac_f32_32x32x32_bf16 v[2:17], v[104:107], v[28:35], v116
    ds_read_b128 v[104:107], v118 offset:7488
    v_exp_f32 v38, v38
    v_exp_f32 v39, v39
    v_exp_f32 v40, v40
    v_mfma_f32_32x32x16_bf16 v[52:67], v[92:95], v[84:87], v[52:67]
    ds_read2st64_b64 v[92:95], v117 offset0:144 offset1:145
    v_exp_f32 v41, v41
    v_exp_f32 v42, v42
    v_exp_f32 v43, v43
    v_exp_f32 v44, v44
    v_mfma_f32_32x32x16_bf16 v[68:83], v[96:99], v[84:87], v[68:83]
    ds_read2st64_b64 v[96:99], v117 offset0:146 offset1:147
    v_exp_f32 v45, v45
    v_exp_f32 v46, v46
    v_exp_f32 v47, v47
    v_smfmac_f32_32x32x32_bf16 v[2:17], v[108:111], v[36:43], v116
    ds_read_b128 v[108:111], v118 offset:8064
    v_exp_f32 v48, v48
    v_exp_f32 v49, v49
    v_exp_f32 v50, v50
    v_exp_f32 v51, v51
    s_waitcnt lgkmcnt(0)
    v_exp_f32 v52, v52
    v_exp_f32 v53, v53
    v_smfmac_f32_32x32x32_bf16 v[2:17], v[112:115], v[44:51], v116
    ds_read_b128 v[112:115], v118 offset:8640
    v_exp_f32 v54, v54
    v_exp_f32 v55, v55
    v_exp_f32 v56, v56
    v_exp_f32 v57, v57
    v_exp_f32 v58, v58
    v_exp_f32 v59, v59
    v_mfma_f32_32x32x4_2b_bf16 v[20:51], v[90:91], v[88:89], 0
    ds_read_b32 v90, v119 offset:26880
    v_exp_f32 v60, v60
    v_exp_f32 v61, v61
    v_exp_f32 v62, v62
    v_exp_f32 v63, v63
    v_exp_f32 v64, v64
    v_exp_f32 v65, v65
    v_exp_f32 v66, v66
    v_smfmac_f32_32x32x32_bf16 v[2:17], v[100:103], v[52:59], v116
    v_add_u32 v118, v120, v118
    ds_read_b128 v[100:103], v118 offset:0
    v_exp_f32 v67, v67
    v_exp_f32 v68, v68
    v_exp_f32 v69, v69
    v_smfmac_f32_32x32x32_bf16 v[2:17], v[104:107], v[60:67], v116
    ds_read_b128 v[104:107], v118 offset:576
    v_exp_f32 v70, v70
    v_exp_f32 v71, v71
    v_exp_f32 v72, v72
    v_mfma_f32_32x32x16_bf16 v[20:35], v[92:95], v[84:87], v[20:35]
    ds_read2st64_b64 v[92:95], v117 offset0:148 offset1:149
    v_exp_f32 v73, v73
    v_exp_f32 v74, v74
    v_exp_f32 v75, v75
    v_exp_f32 v76, v76
    v_mfma_f32_32x32x16_bf16 v[36:51], v[96:99], v[84:87], v[36:51]
    ds_read2st64_b64 v[96:99], v117 offset0:150 offset1:151
    v_exp_f32 v77, v77
    v_exp_f32 v78, v78
    v_exp_f32 v79, v79
    v_smfmac_f32_32x32x32_bf16 v[2:17], v[108:111], v[68:75], v116
    ds_read_b128 v[108:111], v118 offset:1152
    v_exp_f32 v80, v80
    v_exp_f32 v81, v81
    v_exp_f32 v82, v82
    v_exp_f32 v83, v83
    s_waitcnt lgkmcnt(0)
    v_exp_f32 v20, v20
    v_exp_f32 v21, v21
    v_smfmac_f32_32x32x32_bf16 v[2:17], v[112:115], v[76:83], v116
    ds_read_b128 v[112:115], v118 offset:1728
    v_exp_f32 v22, v22
    v_exp_f32 v23, v23
    v_exp_f32 v24, v24
    v_exp_f32 v25, v25
    v_exp_f32 v26, v26
    v_exp_f32 v27, v27
    v_mfma_f32_32x32x4_2b_bf16 v[52:83], v[90:91], v[88:89], 0
    ds_read_b32 v90, v119 offset:27136
    v_exp_f32 v28, v28
    v_exp_f32 v29, v29
    v_exp_f32 v30, v30
    v_exp_f32 v31, v31
    v_exp_f32 v32, v32
    v_exp_f32 v33, v33
    v_exp_f32 v34, v34
    v_smfmac_f32_32x32x32_bf16 v[2:17], v[100:103], v[20:27], v116
    ds_read_b128 v[100:103], v118 offset:2304
    v_exp_f32 v35, v35
    v_exp_f32 v36, v36
    v_exp_f32 v37, v37
    v_smfmac_f32_32x32x32_bf16 v[2:17], v[104:107], v[28:35], v116
    ds_read_b128 v[104:107], v118 offset:2880
    v_exp_f32 v38, v38
    v_exp_f32 v39, v39
    v_exp_f32 v40, v40
    v_mfma_f32_32x32x16_bf16 v[52:67], v[92:95], v[84:87], v[52:67]
    ds_read2st64_b64 v[92:95], v117 offset0:152 offset1:153
    v_exp_f32 v41, v41
    v_exp_f32 v42, v42
    v_exp_f32 v43, v43
    v_exp_f32 v44, v44
    v_mfma_f32_32x32x16_bf16 v[68:83], v[96:99], v[84:87], v[68:83]
    ds_read2st64_b64 v[96:99], v117 offset0:154 offset1:155
    v_exp_f32 v45, v45
    v_exp_f32 v46, v46
    v_exp_f32 v47, v47
    v_smfmac_f32_32x32x32_bf16 v[2:17], v[108:111], v[36:43], v116
    ds_read_b128 v[108:111], v118 offset:3456
    v_exp_f32 v48, v48
    v_exp_f32 v49, v49
    v_exp_f32 v50, v50
    v_exp_f32 v51, v51
    s_waitcnt lgkmcnt(0)
    v_exp_f32 v52, v52
    v_exp_f32 v53, v53
    v_smfmac_f32_32x32x32_bf16 v[2:17], v[112:115], v[44:51], v116
    ds_read_b128 v[112:115], v118 offset:4032
    v_exp_f32 v54, v54
    v_exp_f32 v55, v55
    v_exp_f32 v56, v56
    v_exp_f32 v57, v57
    v_exp_f32 v58, v58
    v_exp_f32 v59, v59
    v_mfma_f32_32x32x4_2b_bf16 v[20:51], v[90:91], v[88:89], 0
    ds_read_b32 v90, v119 offset:27392
    v_exp_f32 v60, v60
    v_exp_f32 v61, v61
    v_exp_f32 v62, v62
    v_exp_f32 v63, v63
    v_exp_f32 v64, v64
    v_exp_f32 v65, v65
    v_exp_f32 v66, v66
    v_smfmac_f32_32x32x32_bf16 v[2:17], v[100:103], v[52:59], v116
    ds_read_b128 v[100:103], v118 offset:4608
    v_exp_f32 v67, v67
    v_exp_f32 v68, v68
    v_exp_f32 v69, v69
    v_smfmac_f32_32x32x32_bf16 v[2:17], v[104:107], v[60:67], v116
    ds_read_b128 v[104:107], v118 offset:5184
    v_exp_f32 v70, v70
    v_exp_f32 v71, v71
    v_exp_f32 v72, v72
    v_mfma_f32_32x32x16_bf16 v[20:35], v[92:95], v[84:87], v[20:35]
    ds_read2st64_b64 v[92:95], v117 offset0:156 offset1:157
    v_exp_f32 v73, v73
    v_exp_f32 v74, v74
    v_exp_f32 v75, v75
    v_exp_f32 v76, v76
    v_mfma_f32_32x32x16_bf16 v[36:51], v[96:99], v[84:87], v[36:51]
    ds_read2st64_b64 v[96:99], v117 offset0:158 offset1:159
    v_exp_f32 v77, v77
    v_exp_f32 v78, v78
    v_exp_f32 v79, v79
    v_smfmac_f32_32x32x32_bf16 v[2:17], v[108:111], v[68:75], v116
    ds_read_b128 v[108:111], v118 offset:5760
    ds_read_b32 v129, v128 offset:8
    v_exp_f32 v80, v80
    v_exp_f32 v81, v81
    v_exp_f32 v82, v82
    v_exp_f32 v83, v83
    s_waitcnt lgkmcnt(0)
    v_readfirstlane_b32 s66, v129
    v_exp_f32 v20, v20
    v_exp_f32 v21, v21
    s_cmp_ge_u32 s66, 8
    s_cbranch_scc0 A_W18
A_R18:
    v_smfmac_f32_32x32x32_bf16 v[2:17], v[112:115], v[76:83], v116
    ds_read_b128 v[112:115], v118 offset:6336
    v_exp_f32 v22, v22
    v_exp_f32 v23, v23
    v_exp_f32 v24, v24
    v_exp_f32 v25, v25
    v_exp_f32 v26, v26
    v_exp_f32 v27, v27
    v_mfma_f32_32x32x4_2b_bf16 v[52:83], v[90:91], v[88:89], 0
    ds_read_b32 v90, v119 offset:45056
    v_exp_f32 v28, v28
    v_exp_f32 v29, v29
    v_exp_f32 v30, v30
    v_exp_f32 v31, v31
    v_exp_f32 v32, v32
    v_exp_f32 v33, v33
    v_exp_f32 v34, v34
    v_smfmac_f32_32x32x32_bf16 v[2:17], v[100:103], v[20:27], v116
    ds_read_b128 v[100:103], v118 offset:6912
    v_exp_f32 v35, v35
    v_exp_f32 v36, v36
    v_exp_f32 v37, v37
    v_smfmac_f32_32x32x32_bf16 v[2:17], v[104:107], v[28:35], v116
    ds_read_b128 v[104:107], v118 offset:7488
    v_exp_f32 v38, v38
    v_exp_f32 v39, v39
    v_exp_f32 v40, v40
    v_mfma_f32_32x32x16_bf16 v[52:67], v[92:95], v[84:87], v[52:67]
    ds_read2st64_b64 v[92:95], v117 offset0:180 offset1:181
    v_exp_f32 v41, v41
    v_exp_f32 v42, v42
    v_exp_f32 v43, v43
    v_exp_f32 v44, v44
    v_mfma_f32_32x32x16_bf16 v[68:83], v[96:99], v[84:87], v[68:83]
    ds_read2st64_b64 v[96:99], v117 offset0:182 offset1:183
    v_exp_f32 v45, v45
    v_exp_f32 v46, v46
    v_exp_f32 v47, v47
    v_smfmac_f32_32x32x32_bf16 v[2:17], v[108:111], v[36:43], v116
    ds_read_b128 v[108:111], v118 offset:8064
    v_exp_f32 v48, v48
    v_exp_f32 v49, v49
    v_exp_f32 v50, v50
    v_exp_f32 v51, v51
    s_waitcnt lgkmcnt(0)
    v_exp_f32 v52, v52
    v_exp_f32 v53, v53
    v_smfmac_f32_32x32x32_bf16 v[2:17], v[112:115], v[44:51], v116
    ds_read_b128 v[112:115], v118 offset:8640
    v_exp_f32 v54, v54
    v_exp_f32 v55, v55
    v_exp_f32 v56, v56
    v_exp_f32 v57, v57
    v_exp_f32 v58, v58
    v_exp_f32 v59, v59
    v_mfma_f32_32x32x4_2b_bf16 v[20:51], v[90:91], v[88:89], 0
    ds_read_b32 v90, v119 offset:45312
    v_exp_f32 v60, v60
    v_exp_f32 v61, v61
    v_exp_f32 v62, v62
    v_exp_f32 v63, v63
    v_exp_f32 v64, v64
    v_exp_f32 v65, v65
    v_exp_f32 v66, v66
    v_smfmac_f32_32x32x32_bf16 v[2:17], v[100:103], v[52:59], v116
    v_add_u32 v118, v120, v118
    ds_read_b128 v[100:103], v118 offset:0
    v_exp_f32 v67, v67
    v_exp_f32 v68, v68
    v_exp_f32 v69, v69
    v_smfmac_f32_32x32x32_bf16 v[2:17], v[104:107], v[60:67], v116
    ds_read_b128 v[104:107], v118 offset:576
    v_exp_f32 v70, v70
    v_exp_f32 v71, v71
    v_exp_f32 v72, v72
    v_mfma_f32_32x32x16_bf16 v[20:35], v[92:95], v[84:87], v[20:35]
    ds_read2st64_b64 v[92:95], v117 offset0:184 offset1:185
    v_exp_f32 v73, v73
    v_exp_f32 v74, v74
    v_exp_f32 v75, v75
    v_exp_f32 v76, v76
    v_mfma_f32_32x32x16_bf16 v[36:51], v[96:99], v[84:87], v[36:51]
    ds_read2st64_b64 v[96:99], v117 offset0:186 offset1:187
    v_exp_f32 v77, v77
    v_exp_f32 v78, v78
    v_exp_f32 v79, v79
    v_smfmac_f32_32x32x32_bf16 v[2:17], v[108:111], v[68:75], v116
    ds_read_b128 v[108:111], v118 offset:1152
    v_exp_f32 v80, v80
    v_exp_f32 v81, v81
    v_exp_f32 v82, v82
    v_exp_f32 v83, v83
    s_waitcnt lgkmcnt(0)
    v_mov_b32 v122, 2
    s_mov_b64 exec, 1
    ds_write_b32 v130, v122 offset:48
    s_mov_b64 exec, -1
    v_exp_f32 v20, v20
    v_exp_f32 v21, v21
    v_smfmac_f32_32x32x32_bf16 v[2:17], v[112:115], v[76:83], v116
    ds_read_b128 v[112:115], v118 offset:1728
    v_exp_f32 v22, v22
    v_exp_f32 v23, v23
    v_exp_f32 v24, v24
    v_exp_f32 v25, v25
    v_exp_f32 v26, v26
    v_exp_f32 v27, v27
    v_mfma_f32_32x32x4_2b_bf16 v[52:83], v[90:91], v[88:89], 0
    ds_read_b32 v90, v119 offset:45568
    v_exp_f32 v28, v28
    v_exp_f32 v29, v29
    v_exp_f32 v30, v30
    v_exp_f32 v31, v31
    v_exp_f32 v32, v32
    v_exp_f32 v33, v33
    v_exp_f32 v34, v34
    v_smfmac_f32_32x32x32_bf16 v[2:17], v[100:103], v[20:27], v116
    ds_read_b128 v[100:103], v118 offset:2304
    v_exp_f32 v35, v35
    v_exp_f32 v36, v36
    v_exp_f32 v37, v37
    v_smfmac_f32_32x32x32_bf16 v[2:17], v[104:107], v[28:35], v116
    ds_read_b128 v[104:107], v118 offset:2880
    v_exp_f32 v38, v38
    v_exp_f32 v39, v39
    v_exp_f32 v40, v40
    v_mfma_f32_32x32x16_bf16 v[52:67], v[92:95], v[84:87], v[52:67]
    ds_read2st64_b64 v[92:95], v117 offset0:188 offset1:189
    v_exp_f32 v41, v41
    v_exp_f32 v42, v42
    v_exp_f32 v43, v43
    v_exp_f32 v44, v44
    v_mfma_f32_32x32x16_bf16 v[68:83], v[96:99], v[84:87], v[68:83]
    ds_read2st64_b64 v[96:99], v117 offset0:190 offset1:191
    v_exp_f32 v45, v45
    v_exp_f32 v46, v46
    v_exp_f32 v47, v47
    v_smfmac_f32_32x32x32_bf16 v[2:17], v[108:111], v[36:43], v116
    ds_read_b128 v[108:111], v118 offset:3456
    v_exp_f32 v48, v48
    v_exp_f32 v49, v49
    v_exp_f32 v50, v50
    v_exp_f32 v51, v51
    s_waitcnt lgkmcnt(0)
    v_exp_f32 v52, v52
    v_exp_f32 v53, v53
    v_smfmac_f32_32x32x32_bf16 v[2:17], v[112:115], v[44:51], v116
    ds_read_b128 v[112:115], v118 offset:4032
    v_exp_f32 v54, v54
    v_exp_f32 v55, v55
    v_exp_f32 v56, v56
    v_exp_f32 v57, v57
    v_exp_f32 v58, v58
    v_exp_f32 v59, v59
    v_mfma_f32_32x32x4_2b_bf16 v[20:51], v[90:91], v[88:89], 0
    ds_read_b32 v90, v119 offset:45824
    v_exp_f32 v60, v60
    v_exp_f32 v61, v61
    v_exp_f32 v62, v62
    v_exp_f32 v63, v63
    v_exp_f32 v64, v64
    v_exp_f32 v65, v65
    v_exp_f32 v66, v66
    v_smfmac_f32_32x32x32_bf16 v[2:17], v[100:103], v[52:59], v116
    ds_read_b128 v[100:103], v118 offset:4608
    v_exp_f32 v67, v67
    v_exp_f32 v68, v68
    v_exp_f32 v69, v69
    v_smfmac_f32_32x32x32_bf16 v[2:17], v[104:107], v[60:67], v116
    ds_read_b128 v[104:107], v118 offset:5184
    v_exp_f32 v70, v70
    v_exp_f32 v71, v71
    v_exp_f32 v72, v72
    v_mfma_f32_32x32x16_bf16 v[20:35], v[92:95], v[84:87], v[20:35]
    ds_read2st64_b64 v[92:95], v117 offset0:192 offset1:193
    v_exp_f32 v73, v73
    v_exp_f32 v74, v74
    v_exp_f32 v75, v75
    v_exp_f32 v76, v76
    v_mfma_f32_32x32x16_bf16 v[36:51], v[96:99], v[84:87], v[36:51]
    ds_read2st64_b64 v[96:99], v117 offset0:194 offset1:195
    v_exp_f32 v77, v77
    v_exp_f32 v78, v78
    v_exp_f32 v79, v79
    v_smfmac_f32_32x32x32_bf16 v[2:17], v[108:111], v[68:75], v116
    ds_read_b128 v[108:111], v118 offset:5760
    v_exp_f32 v80, v80
    v_exp_f32 v81, v81
    v_exp_f32 v82, v82
    v_exp_f32 v83, v83
    s_waitcnt lgkmcnt(0)
    s_cbranch_vccz A_P1
    s_setprio 0
A_P1:
    v_exp_f32 v20, v20
    v_exp_f32 v21, v21
    v_smfmac_f32_32x32x32_bf16 v[2:17], v[112:115], v[76:83], v116
    ds_read_b128 v[112:115], v118 offset:6336
    v_exp_f32 v22, v22
    v_exp_f32 v23, v23
    v_exp_f32 v24, v24
    v_exp_f32 v25, v25
    v_exp_f32 v26, v26
    v_exp_f32 v27, v27
    v_mfma_f32_32x32x4_2b_bf16 v[52:83], v[90:91], v[88:89], 0
    ds_read_b32 v90, v119 offset:63488
    v_exp_f32 v28, v28
    v_exp_f32 v29, v29
    v_exp_f32 v30, v30
    v_exp_f32 v31, v31
    v_exp_f32 v32, v32
    v_exp_f32 v33, v33
    v_exp_f32 v34, v34
    v_smfmac_f32_32x32x32_bf16 v[2:17], v[100:103], v[20:27], v116
    ds_read_b128 v[100:103], v118 offset:6912
    v_exp_f32 v35, v35
    v_exp_f32 v36, v36
    v_exp_f32 v37, v37
    v_smfmac_f32_32x32x32_bf16 v[2:17], v[104:107], v[28:35], v116
    ds_read_b128 v[104:107], v118 offset:7488
    v_exp_f32 v38, v38
    v_exp_f32 v39, v39
    v_exp_f32 v40, v40
    v_mfma_f32_32x32x16_bf16 v[52:67], v[92:95], v[84:87], v[52:67]
    ds_read2st64_b64 v[92:95], v117 offset0:216 offset1:217
    v_exp_f32 v41, v41
    v_exp_f32 v42, v42
    v_exp_f32 v43, v43
    v_exp_f32 v44, v44
    v_mfma_f32_32x32x16_bf16 v[68:83], v[96:99], v[84:87], v[68:83]
    ds_read2st64_b64 v[96:99], v117 offset0:218 offset1:219
    v_exp_f32 v45, v45
    v_exp_f32 v46, v46
    v_exp_f32 v47, v47
    v_smfmac_f32_32x32x32_bf16 v[2:17], v[108:111], v[36:43], v116
    ds_read_b128 v[108:111], v118 offset:8064
    v_exp_f32 v48, v48
    v_exp_f32 v49, v49
    v_exp_f32 v50, v50
    v_exp_f32 v51, v51
    s_waitcnt lgkmcnt(0)
    v_exp_f32 v52, v52
    v_exp_f32 v53, v53
    v_smfmac_f32_32x32x32_bf16 v[2:17], v[112:115], v[44:51], v116
    ds_read_b128 v[112:115], v118 offset:8640
    v_exp_f32 v54, v54
    v_exp_f32 v55, v55
    v_exp_f32 v56, v56
    v_exp_f32 v57, v57
    v_exp_f32 v58, v58
    v_exp_f32 v59, v59
    v_mfma_f32_32x32x4_2b_bf16 v[20:51], v[90:91], v[88:89], 0
    ds_read_b32 v90, v119 offset:63744
    v_exp_f32 v60, v60
    v_exp_f32 v61, v61
    v_exp_f32 v62, v62
    v_exp_f32 v63, v63
    v_exp_f32 v64, v64
    v_exp_f32 v65, v65
    v_exp_f32 v66, v66
    v_smfmac_f32_32x32x32_bf16 v[2:17], v[100:103], v[52:59], v116
    v_add_u32 v118, v120, v118
    ds_read_b128 v[100:103], v118 offset:0
    v_exp_f32 v67, v67
    v_exp_f32 v68, v68
    v_exp_f32 v69, v69
    v_smfmac_f32_32x32x32_bf16 v[2:17], v[104:107], v[60:67], v116
    ds_read_b128 v[104:107], v118 offset:576
    v_exp_f32 v70, v70
    v_exp_f32 v71, v71
    v_exp_f32 v72, v72
    v_mfma_f32_32x32x16_bf16 v[20:35], v[92:95], v[84:87], v[20:35]
    ds_read2st64_b64 v[92:95], v117 offset0:220 offset1:221
    v_exp_f32 v73, v73
    v_exp_f32 v74, v74
    v_exp_f32 v75, v75
    v_exp_f32 v76, v76
    v_mfma_f32_32x32x16_bf16 v[36:51], v[96:99], v[84:87], v[36:51]
    ds_read2st64_b64 v[96:99], v117 offset0:222 offset1:223
    v_exp_f32 v77, v77
    v_exp_f32 v78, v78
    v_exp_f32 v79, v79
    v_smfmac_f32_32x32x32_bf16 v[2:17], v[108:111], v[68:75], v116
    ds_read_b128 v[108:111], v118 offset:1152
    v_exp_f32 v80, v80
    v_exp_f32 v81, v81
    v_exp_f32 v82, v82
    v_exp_f32 v83, v83
    s_waitcnt lgkmcnt(0)
    buffer_load_dword v121, v121, s[16:19], s29 offen sc1
    buffer_load_dword v155, v155, s[16:19], s51 offen sc1
    v_exp_f32 v20, v20
    v_exp_f32 v21, v21
    v_smfmac_f32_32x32x32_bf16 v[2:17], v[112:115], v[76:83], v116
    ds_read_b128 v[112:115], v118 offset:1728
    v_exp_f32 v22, v22
    v_exp_f32 v23, v23
    v_exp_f32 v24, v24
    v_exp_f32 v25, v25
    v_exp_f32 v26, v26
    v_exp_f32 v27, v27
    v_mfma_f32_32x32x4_2b_bf16 v[52:83], v[90:91], v[88:89], 0
    ds_read_b32 v90, v119 offset:64000
    v_exp_f32 v28, v28
    v_exp_f32 v29, v29
    v_exp_f32 v30, v30
    v_exp_f32 v31, v31
    v_exp_f32 v32, v32
    v_exp_f32 v33, v33
    v_exp_f32 v34, v34
    v_smfmac_f32_32x32x32_bf16 v[2:17], v[100:103], v[20:27], v116
    ds_read_b128 v[100:103], v118 offset:2304
    v_exp_f32 v35, v35
    v_exp_f32 v36, v36
    v_exp_f32 v37, v37
    v_smfmac_f32_32x32x32_bf16 v[2:17], v[104:107], v[28:35], v116
    ds_read_b128 v[104:107], v118 offset:2880
    v_exp_f32 v38, v38
    v_exp_f32 v39, v39
    v_exp_f32 v40, v40
    v_mfma_f32_32x32x16_bf16 v[52:67], v[92:95], v[84:87], v[52:67]
    ds_read2st64_b64 v[92:95], v117 offset0:224 offset1:225
    v_exp_f32 v41, v41
    v_exp_f32 v42, v42
    v_exp_f32 v43, v43
    v_exp_f32 v44, v44
    v_mfma_f32_32x32x16_bf16 v[68:83], v[96:99], v[84:87], v[68:83]
    ds_read2st64_b64 v[96:99], v117 offset0:226 offset1:227
    v_exp_f32 v45, v45
    v_exp_f32 v46, v46
    v_exp_f32 v47, v47
    v_smfmac_f32_32x32x32_bf16 v[2:17], v[108:111], v[36:43], v116
    ds_read_b128 v[108:111], v118 offset:3456
    v_exp_f32 v48, v48
    v_exp_f32 v49, v49
    v_exp_f32 v50, v50
    v_exp_f32 v51, v51
    s_waitcnt lgkmcnt(0)
    v_exp_f32 v52, v52
    v_exp_f32 v53, v53
    v_smfmac_f32_32x32x32_bf16 v[2:17], v[112:115], v[44:51], v116
    ds_read_b128 v[112:115], v118 offset:4032
    v_exp_f32 v54, v54
    v_exp_f32 v55, v55
    v_exp_f32 v56, v56
    v_exp_f32 v57, v57
    v_exp_f32 v58, v58
    v_exp_f32 v59, v59
    v_mfma_f32_32x32x4_2b_bf16 v[20:51], v[90:91], v[88:89], 0
    ds_read_b32 v90, v119 offset:64256
    v_exp_f32 v60, v60
    v_exp_f32 v61, v61
    v_exp_f32 v62, v62
    v_exp_f32 v63, v63
    v_exp_f32 v64, v64
    v_exp_f32 v65, v65
    v_exp_f32 v66, v66
    v_smfmac_f32_32x32x32_bf16 v[2:17], v[100:103], v[52:59], v116
    ds_read_b128 v[100:103], v118 offset:4608
    v_exp_f32 v67, v67
    v_exp_f32 v68, v68
    v_exp_f32 v69, v69
    v_smfmac_f32_32x32x32_bf16 v[2:17], v[104:107], v[60:67], v116
    ds_read_b128 v[104:107], v118 offset:5184
    v_exp_f32 v70, v70
    v_exp_f32 v71, v71
    v_exp_f32 v72, v72
    v_mfma_f32_32x32x16_bf16 v[20:35], v[92:95], v[84:87], v[20:35]
    ds_read2st64_b64 v[92:95], v117 offset0:228 offset1:229
    v_exp_f32 v73, v73
    v_exp_f32 v74, v74
    v_exp_f32 v75, v75
    v_exp_f32 v76, v76
    v_mfma_f32_32x32x16_bf16 v[36:51], v[96:99], v[84:87], v[36:51]
    ds_read2st64_b64 v[96:99], v117 offset0:230 offset1:231
    v_exp_f32 v77, v77
    v_exp_f32 v78, v78
    v_exp_f32 v79, v79
    v_smfmac_f32_32x32x32_bf16 v[2:17], v[108:111], v[68:75], v116
    ds_read_b128 v[108:111], v118 offset:5760
    v_exp_f32 v80, v80
    v_exp_f32 v81, v81
    v_exp_f32 v82, v82
    v_exp_f32 v83, v83
    s_waitcnt lgkmcnt(0)
    v_exp_f32 v20, v20
    v_exp_f32 v21, v21
    v_smfmac_f32_32x32x32_bf16 v[2:17], v[112:115], v[76:83], v116
    ds_read_b128 v[112:115], v118 offset:6336
    v_add_u32 v119, 55296, v119
    v_add_u32 v117, 73728, v117
    v_exp_f32 v22, v22
    v_exp_f32 v23, v23
    v_exp_f32 v24, v24
    v_exp_f32 v25, v25
    v_exp_f32 v26, v26
    v_exp_f32 v27, v27
    v_mfma_f32_32x32x4_2b_bf16 v[52:83], v[90:91], v[88:89], 0
    ds_read_b32 v90, v119 offset:26624
    v_exp_f32 v28, v28
    v_exp_f32 v29, v29
    v_exp_f32 v30, v30
    v_exp_f32 v31, v31
    v_exp_f32 v32, v32
    v_exp_f32 v33, v33
    v_exp_f32 v34, v34
    v_smfmac_f32_32x32x32_bf16 v[2:17], v[100:103], v[20:27], v116
    ds_read_b128 v[100:103], v118 offset:6912
    v_exp_f32 v35, v35
    v_exp_f32 v36, v36
    v_exp_f32 v37, v37
    v_smfmac_f32_32x32x32_bf16 v[2:17], v[104:107], v[28:35], v116
    ds_read_b128 v[104:107], v118 offset:7488
    v_exp_f32 v38, v38
    v_exp_f32 v39, v39
    v_exp_f32 v40, v40
    v_mfma_f32_32x32x16_bf16 v[52:67], v[92:95], v[84:87], v[52:67]
    ds_read2st64_b64 v[92:95], v117 offset0:108 offset1:109
    v_exp_f32 v41, v41
    v_exp_f32 v42, v42
    v_exp_f32 v43, v43
    v_exp_f32 v44, v44
    v_mfma_f32_32x32x16_bf16 v[68:83], v[96:99], v[84:87], v[68:83]
    ds_read2st64_b64 v[96:99], v117 offset0:110 offset1:111
    v_exp_f32 v45, v45
    v_exp_f32 v46, v46
    v_exp_f32 v47, v47
    v_smfmac_f32_32x32x32_bf16 v[2:17], v[108:111], v[36:43], v116
    ds_read_b128 v[108:111], v118 offset:8064
    v_exp_f32 v48, v48
    v_exp_f32 v49, v49
    v_exp_f32 v50, v50
    v_exp_f32 v51, v51
    s_waitcnt lgkmcnt(0)
    v_exp_f32 v52, v52
    v_exp_f32 v53, v53
    v_smfmac_f32_32x32x32_bf16 v[2:17], v[112:115], v[44:51], v116
    ds_read_b128 v[112:115], v118 offset:8640
    v_exp_f32 v54, v54
    v_exp_f32 v55, v55
    v_exp_f32 v56, v56
    v_exp_f32 v57, v57
    v_exp_f32 v58, v58
    v_exp_f32 v59, v59
    v_mfma_f32_32x32x4_2b_bf16 v[20:51], v[90:91], v[88:89], 0
    ds_read_b32 v90, v119 offset:26880
    v_exp_f32 v60, v60
    v_exp_f32 v61, v61
    v_exp_f32 v62, v62
    v_exp_f32 v63, v63
    v_exp_f32 v64, v64
    v_exp_f32 v65, v65
    v_exp_f32 v66, v66
    v_smfmac_f32_32x32x32_bf16 v[2:17], v[100:103], v[52:59], v116
    v_add_u32 v118, v120, v118
    ds_read_b128 v[100:103], v118 offset:0
    v_exp_f32 v67, v67
    v_exp_f32 v68, v68
    v_exp_f32 v69, v69
    v_smfmac_f32_32x32x32_bf16 v[2:17], v[104:107], v[60:67], v116
    ds_read_b128 v[104:107], v118 offset:576
    v_exp_f32 v70, v70
    v_exp_f32 v71, v71
    v_exp_f32 v72, v72
    v_mfma_f32_32x32x16_bf16 v[20:35], v[92:95], v[84:87], v[20:35]
    ds_read2st64_b64 v[92:95], v117 offset0:112 offset1:113
    v_exp_f32 v73, v73
    v_exp_f32 v74, v74
    v_exp_f32 v75, v75
    v_exp_f32 v76, v76
    v_mfma_f32_32x32x16_bf16 v[36:51], v[96:99], v[84:87], v[36:51]
    ds_read2st64_b64 v[96:99], v117 offset0:114 offset1:115
    v_exp_f32 v77, v77
    v_exp_f32 v78, v78
    v_exp_f32 v79, v79
    v_smfmac_f32_32x32x32_bf16 v[2:17], v[108:111], v[68:75], v116
    ds_read_b128 v[108:111], v118 offset:1152
    v_exp_f32 v80, v80
    v_exp_f32 v81, v81
    v_exp_f32 v82, v82
    v_exp_f32 v83, v83
    s_waitcnt lgkmcnt(0)
    v_exp_f32 v20, v20
    v_exp_f32 v21, v21
    v_smfmac_f32_32x32x32_bf16 v[2:17], v[112:115], v[76:83], v116
    ds_read_b128 v[112:115], v118 offset:1728
    v_exp_f32 v22, v22
    v_exp_f32 v23, v23
    v_exp_f32 v24, v24
    v_exp_f32 v25, v25
    v_exp_f32 v26, v26
    v_exp_f32 v27, v27
    v_mfma_f32_32x32x4_2b_bf16 v[52:83], v[90:91], v[88:89], 0
    ds_read_b32 v90, v119 offset:27136
    v_exp_f32 v28, v28
    v_exp_f32 v29, v29
    v_exp_f32 v30, v30
    v_exp_f32 v31, v31
    v_exp_f32 v32, v32
    v_exp_f32 v33, v33
    v_exp_f32 v34, v34
    v_smfmac_f32_32x32x32_bf16 v[2:17], v[100:103], v[20:27], v116
    ds_read_b128 v[100:103], v118 offset:2304
    v_exp_f32 v35, v35
    v_exp_f32 v36, v36
    v_exp_f32 v37, v37
    v_smfmac_f32_32x32x32_bf16 v[2:17], v[104:107], v[28:35], v116
    ds_read_b128 v[104:107], v118 offset:2880
    v_exp_f32 v38, v38
    v_exp_f32 v39, v39
    v_exp_f32 v40, v40
    v_mfma_f32_32x32x16_bf16 v[52:67], v[92:95], v[84:87], v[52:67]
    ds_read2st64_b64 v[92:95], v117 offset0:116 offset1:117
    v_exp_f32 v41, v41
    v_exp_f32 v42, v42
    v_exp_f32 v43, v43
    v_exp_f32 v44, v44
    v_mfma_f32_32x32x16_bf16 v[68:83], v[96:99], v[84:87], v[68:83]
    ds_read2st64_b64 v[96:99], v117 offset0:118 offset1:119
    v_exp_f32 v45, v45
    v_exp_f32 v46, v46
    v_exp_f32 v47, v47
    v_smfmac_f32_32x32x32_bf16 v[2:17], v[108:111], v[36:43], v116
    ds_read_b128 v[108:111], v118 offset:3456
    v_exp_f32 v48, v48
    v_exp_f32 v49, v49
    v_exp_f32 v50, v50
    v_exp_f32 v51, v51
    s_waitcnt lgkmcnt(0)
    v_exp_f32 v52, v52
    v_exp_f32 v53, v53
    v_smfmac_f32_32x32x32_bf16 v[2:17], v[112:115], v[44:51], v116
    ds_read_b128 v[112:115], v118 offset:4032
    v_exp_f32 v54, v54
    v_exp_f32 v55, v55
    v_exp_f32 v56, v56
    v_exp_f32 v57, v57
    v_exp_f32 v58, v58
    v_exp_f32 v59, v59
    v_mfma_f32_32x32x4_2b_bf16 v[20:51], v[90:91], v[88:89], 0
    ds_read_b32 v90, v119 offset:27392
    v_exp_f32 v60, v60
    v_exp_f32 v61, v61
    v_exp_f32 v62, v62
    v_exp_f32 v63, v63
    v_exp_f32 v64, v64
    v_exp_f32 v65, v65
    v_exp_f32 v66, v66
    v_smfmac_f32_32x32x32_bf16 v[2:17], v[100:103], v[52:59], v116
    ds_read_b128 v[100:103], v118 offset:4608
    v_exp_f32 v67, v67
    v_exp_f32 v68, v68
    v_exp_f32 v69, v69
    v_smfmac_f32_32x32x32_bf16 v[2:17], v[104:107], v[60:67], v116
    ds_read_b128 v[104:107], v118 offset:5184
    v_exp_f32 v70, v70
    v_exp_f32 v71, v71
    v_exp_f32 v72, v72
    v_mfma_f32_32x32x16_bf16 v[20:35], v[92:95], v[84:87], v[20:35]
    ds_read2st64_b64 v[92:95], v117 offset0:120 offset1:121
    v_exp_f32 v73, v73
    v_exp_f32 v74, v74
    v_exp_f32 v75, v75
    v_exp_f32 v76, v76
    v_mfma_f32_32x32x16_bf16 v[36:51], v[96:99], v[84:87], v[36:51]
    ds_read2st64_b64 v[96:99], v117 offset0:122 offset1:123
    v_exp_f32 v77, v77
    v_exp_f32 v78, v78
    v_exp_f32 v79, v79
    v_smfmac_f32_32x32x32_bf16 v[2:17], v[108:111], v[68:75], v116
    ds_read_b128 v[108:111], v118 offset:5760
    v_exp_f32 v80, v80
    v_exp_f32 v81, v81
    v_exp_f32 v82, v82
    v_exp_f32 v83, v83
    s_waitcnt lgkmcnt(0)
    v_exp_f32 v20, v20
    v_exp_f32 v21, v21
    v_smfmac_f32_32x32x32_bf16 v[2:17], v[112:115], v[76:83], v116
    ds_read_b128 v[112:115], v118 offset:6336
    v_exp_f32 v22, v22
    v_exp_f32 v23, v23
    v_exp_f32 v24, v24
    v_exp_f32 v25, v25
    v_exp_f32 v26, v26
    v_exp_f32 v27, v27
    v_mfma_f32_32x32x4_2b_bf16 v[52:83], v[90:91], v[88:89], 0
    s_nop 0
    v_exp_f32 v28, v28
    v_exp_f32 v29, v29
    v_exp_f32 v30, v30
    v_exp_f32 v31, v31
    v_exp_f32 v32, v32
    v_exp_f32 v33, v33
    v_exp_f32 v34, v34
    v_smfmac_f32_32x32x32_bf16 v[2:17], v[100:103], v[20:27], v116
    ds_read_b128 v[100:103], v118 offset:6912
    v_exp_f32 v35, v35
    v_exp_f32 v36, v36
    v_exp_f32 v37, v37
    v_smfmac_f32_32x32x32_bf16 v[2:17], v[104:107], v[28:35], v116
    ds_read_b128 v[104:107], v118 offset:7488
    v_exp_f32 v38, v38
    v_exp_f32 v39, v39
    v_exp_f32 v40, v40
    v_mfma_f32_32x32x16_bf16 v[52:67], v[92:95], v[84:87], v[52:67]
    v_exp_f32 v41, v41
    v_exp_f32 v42, v42
    v_exp_f32 v43, v43
    v_exp_f32 v44, v44
    v_mfma_f32_32x32x16_bf16 v[68:83], v[96:99], v[84:87], v[68:83]
    v_exp_f32 v45, v45
    v_exp_f32 v46, v46
    v_exp_f32 v47, v47
    v_smfmac_f32_32x32x32_bf16 v[2:17], v[108:111], v[36:43], v116
    ds_read_b128 v[108:111], v118 offset:8064
    v_exp_f32 v48, v48
    v_exp_f32 v49, v49
    v_exp_f32 v50, v50
    v_exp_f32 v51, v51
    s_nop 1
    s_waitcnt lgkmcnt(0)
    v_exp_f32 v52, v52
    v_exp_f32 v53, v53
    v_smfmac_f32_32x32x32_bf16 v[2:17], v[112:115], v[44:51], v116
    ds_read_b128 v[112:115], v118 offset:8640
    v_exp_f32 v54, v54
    v_exp_f32 v55, v55
    v_exp_f32 v56, v56
    v_exp_f32 v57, v57
    v_exp_f32 v58, v58
    v_exp_f32 v59, v59
    v_exp_f32 v60, v60
    v_exp_f32 v61, v61
    v_exp_f32 v62, v62
    v_exp_f32 v63, v63
    v_exp_f32 v64, v64
    v_exp_f32 v65, v65
    v_exp_f32 v66, v66
    v_smfmac_f32_32x32x32_bf16 v[2:17], v[100:103], v[52:59], v116
    v_exp_f32 v67, v67
    v_exp_f32 v68, v68
    v_exp_f32 v69, v69
    v_smfmac_f32_32x32x32_bf16 v[2:17], v[104:107], v[60:67], v116
    v_exp_f32 v70, v70
    v_exp_f32 v71, v71
    v_exp_f32 v72, v72
    v_exp_f32 v73, v73
    v_exp_f32 v74, v74
    v_exp_f32 v75, v75
    v_exp_f32 v76, v76
    v_exp_f32 v77, v77
    v_exp_f32 v78, v78
    v_exp_f32 v79, v79
    v_smfmac_f32_32x32x32_bf16 v[2:17], v[108:111], v[68:75], v116
    v_exp_f32 v80, v80
    v_exp_f32 v81, v81
    v_exp_f32 v82, v82
    v_exp_f32 v83, v83
    s_waitcnt vmcnt(0) lgkmcnt(0)
    s_nop 0
    v_smfmac_f32_32x32x32_bf16 v[2:17], v[112:115], v[76:83], v116
    s_setprio 3
    v_lshlrev_b32 v117, 4, v1
    v_lshlrev_b32 v119, 2, v1
    v_mov_b32 v92, 0
    v_mov_b32 v93, s60
    s_mov_b32 s31, 0x5f800000
    s_mov_b32 s34, 0x1f800000
    s_nop 4
    v_cmp_nge_f32 s[32:33], s31, v12
    v_cmp_gt_f32 s[34:35], s34, v12
    v_rcp_f32 v122, v12
    s_or_b64 s[32:33], s[32:33], s[34:35]
    s_cbranch_scc1 A_SLOW
A_FIN:
    v_mul_f32 v122, v122, v121
    v_mul_f32 v2, v2, v122
    v_mul_f32 v3, v3, v122
    v_mul_f32 v4, v4, v122
    v_mul_f32 v5, v5, v122
    v_mul_f32 v6, v6, v122
    v_mul_f32 v7, v7, v122
    v_mul_f32 v8, v8, v122
    v_mul_f32 v9, v9, v122
    v_cvt_pk_bf16_f32 v20, v2, v3
    v_cvt_pk_bf16_f32 v21, v4, v5
    v_cvt_pk_bf16_f32 v22, v6, v7
    v_cvt_pk_bf16_f32 v23, v8, v9
    buffer_store_dwordx4 v[20:23], v117, s[16:19], s53 offen sc1
    v_mul_f32 v10, v10, v122
    v_mul_f32 v11, v11, v122
    v_cvt_pk_bf16_f32 v24, v10, v11
    s_mov_b64 exec, 0xffffffff
    buffer_store_dword v24, v119, s[16:19], s54 offen sc1
    s_mov_b64 exec, -1
    s_cbranch_vccnz P3_GO
    s_waitcnt vmcnt(0)
    s_mov_b64 exec, 1
    buffer_atomic_swap v93, v92, s[16:19], s55 offen sc1
    s_mov_b64 exec, -1
    s_endpgm
P3_GO:
    s_mov_b32 s65, 160000
LL_WO:
    ds_read_b32 v129, v128 offset:8
    s_waitcnt lgkmcnt(0)
    v_readfirstlane_b32 s66, v129
    s_nop 0
    s_cmp_ge_u32 s66, 9
    s_cbranch_scc1 LD_WO
    s_sleep 1
    s_sub_u32 s65, s65, 1
    s_cmp_lg_u32 s65, 0
    s_cbranch_scc1 LL_WO
LD_WO:
    ds_read_b128 v[126:129], v153 offset:0
    ds_read_b128 v[130:133], v153 offset:2048
    ds_read_b128 v[134:137], v153 offset:4096
    ds_read_b128 v[138:141], v153 offset:6144
    ds_read_b128 v[142:145], v153 offset:8192
    s_load_dwordx2 s[12:13], s[0:1], 104
    v_lshrrev_b32 v48, 16, v155
    s_cmp_eq_u32 s47, 0
    s_cselect_b64 s[78:79], -1, 0
    v_cmp_eq_u32 s[70:71], 0, v159
    v_cmp_eq_u32 s[72:73], 1, v159
    s_nop 0
    v_cndmask_b32 v49, 0, v48, s[70:71]
    v_cndmask_b32 v49, v49, v155, s[72:73]
    v_cndmask_b32 v40, 0, v49, s[78:79]
    v_cndmask_b32 v44, v49, 0, s[78:79]
    v_cmp_eq_u32 s[74:75], 2, v159
    v_cmp_eq_u32 s[76:77], 3, v159
    s_nop 0
    v_cndmask_b32 v49, 0, v48, s[74:75]
    v_cndmask_b32 v49, v49, v155, s[76:77]
    v_cndmask_b32 v41, 0, v49, s[78:79]
    v_cndmask_b32 v45, v49, 0, s[78:79]
    v_cmp_eq_u32 s[70:71], 4, v159
    v_cmp_eq_u32 s[72:73], 5, v159
    s_nop 0
    v_cndmask_b32 v49, 0, v48, s[70:71]
    v_cndmask_b32 v49, v49, v155, s[72:73]
    v_cndmask_b32 v42, 0, v49, s[78:79]
    v_cndmask_b32 v46, v49, 0, s[78:79]
    v_cmp_eq_u32 s[74:75], 6, v159
    v_cmp_eq_u32 s[76:77], 7, v159
    s_nop 0
    v_cndmask_b32 v49, 0, v48, s[74:75]
    v_cndmask_b32 v49, v49, v155, s[76:77]
    v_cndmask_b32 v43, 0, v49, s[78:79]
    v_cndmask_b32 v47, v49, 0, s[78:79]
    s_mov_b32 s14, 2359296
    s_mov_b32 s15, 0x00020000
    s_waitcnt vmcnt(0) lgkmcnt(0)
    s_mov_b64 exec, 1
    buffer_atomic_swap v93, v92, s[16:19], s55 offen sc1
    s_mov_b64 exec, -1
    v_mfma_f32_16x16x32_bf16 v[66:69], v[126:129], v[40:43], 0
    v_mfma_f32_16x16x32_bf16 v[70:73], v[126:129], v[44:47], 0
    v_mfma_f32_16x16x32_bf16 v[74:77], v[130:133], v[40:43], 0
    v_mfma_f32_16x16x32_bf16 v[78:81], v[130:133], v[44:47], 0
    v_mfma_f32_16x16x32_bf16 v[82:85], v[134:137], v[40:43], 0
    v_mfma_f32_16x16x32_bf16 v[86:89], v[134:137], v[44:47], 0
    v_mfma_f32_16x16x32_bf16 v[90:93], v[138:141], v[40:43], 0
    v_mfma_f32_16x16x32_bf16 v[94:97], v[138:141], v[44:47], 0
    v_mfma_f32_16x16x32_bf16 v[98:101], v[142:145], v[40:43], 0
    v_mfma_f32_16x16x32_bf16 v[102:105], v[142:145], v[44:47], 0
    ds_read_b64_tr_b16 v[106:107], v148 offset:0
    ds_read_b64_tr_b16 v[108:109], v148 offset:1152
    ds_read_b64_tr_b16 v[110:111], v148 offset:32
    ds_read_b64_tr_b16 v[112:113], v148 offset:1184
    ds_read_b64_tr_b16 v[114:115], v148 offset:64
    ds_read_b64_tr_b16 v[116:117], v148 offset:1216
    ds_read_b64_tr_b16 v[118:119], v148 offset:96
    ds_read_b64_tr_b16 v[120:121], v148 offset:1248
    ds_read_b64_tr_b16 v[122:123], v148 offset:128
    ds_read_b64_tr_b16 v[124:125], v148 offset:1280
    s_mov_b32 s65, 20000
PL_O:
    s_mov_b64 exec, 0xffff
    v_mov_b32 v9, 0
    buffer_atomic_or v9, v154, s[16:19], 0 offen sc0 sc1
    s_waitcnt vmcnt(0)
    s_mov_b64 exec, 0xffff
    v_cmp_ne_u32 s[66:67], s60, v9
    s_mov_b64 exec, -1
    s_cmp_eq_u64 s[66:67], 0
    s_cbranch_scc1 PD_O
    s_sleep 1
    s_sub_u32 s65, s65, 1
    s_cmp_lg_u32 s65, 0
    s_cbranch_scc1 PL_O
PD_O:
    buffer_load_dwordx4 v[2:5], v150, s[16:19], s49 offen offset:0 sc1
    buffer_load_dwordx4 v[6:9], v150, s[16:19], s49 offen offset:256 sc1
    buffer_load_dwordx4 v[10:13], v150, s[16:19], s49 offen offset:2048 sc1
    buffer_load_dwordx4 v[14:17], v150, s[16:19], s49 offen offset:2304 sc1
    s_add_u32 s49, s49, 4096
    buffer_load_dwordx4 v[18:21], v150, s[16:19], s49 offen offset:0 sc1
    buffer_load_dwordx4 v[22:25], v150, s[16:19], s49 offen offset:256 sc1
    buffer_load_dwordx4 v[26:29], v150, s[16:19], s49 offen offset:2048 sc1
    buffer_load_dwordx4 v[30:33], v150, s[16:19], s49 offen offset:2304 sc1
    s_add_u32 s49, s49, 4096
    buffer_load_dwordx4 v[34:37], v150, s[16:19], s49 offen offset:0 sc1
    buffer_load_dwordx4 v[38:41], v150, s[16:19], s49 offen offset:256 sc1
    buffer_load_dwordx4 v[42:45], v150, s[16:19], s49 offen offset:2048 sc1
    buffer_load_dwordx4 v[46:49], v150, s[16:19], s49 offen offset:2304 sc1
    s_add_u32 s49, s49, 4096
    buffer_load_dwordx4 v[50:53], v150, s[16:19], s49 offen offset:0 sc1
    buffer_load_dwordx4 v[54:57], v150, s[16:19], s49 offen offset:256 sc1
    buffer_load_dwordx4 v[58:61], v150, s[16:19], s49 offen offset:2048 sc1
    buffer_load_dwordx4 v[62:65], v150, s[16:19], s49 offen offset:2304 sc1
    buffer_load_dword v160, v151, s[16:19], s50 offen offset:0 sc1
    buffer_load_dword v161, v151, s[16:19], s50 offen offset:128 sc1
    buffer_load_dword v162, v151, s[16:19], s50 offen offset:256 sc1
    buffer_load_dword v163, v151, s[16:19], s50 offen offset:384 sc1
    buffer_load_dword v164, v151, s[16:19], s50 offen offset:64 sc1
    buffer_load_dword v165, v151, s[16:19], s50 offen offset:192 sc1
    buffer_load_dword v166, v151, s[16:19], s50 offen offset:320 sc1
    buffer_load_dword v167, v151, s[16:19], s50 offen offset:448 sc1
    s_mul_i32 s70, s59, 4864
    s_add_u32 s70, s70, 92160
    v_lshrrev_b32 v146, 16, v156
    v_and_b32 v147, 0xffff, v156
    v_mul_u32_u24 v156, 16, v146
    v_lshl_add_u32 v156, v147, 5, v156
    v_add_u32 v156, s70, v156
    v_mul_u32_u24 v146, 1008, v146
    v_lshl_add_u32 v153, v147, 4, v146
    v_lshrrev_b32 v146, 16, v157
    v_and_b32 v147, 0xffff, v157
    v_mul_u32_u24 v157, 16, v146
    v_lshl_add_u32 v157, v147, 5, v157
    v_add_u32 v157, s70, v157
    v_mul_u32_u24 v146, 1008, v146
    v_lshl_add_u32 v154, v147, 4, v146
    v_lshrrev_b32 v146, 16, v158
    v_and_b32 v147, 0xffff, v158
    v_mul_u32_u24 v158, 16, v146
    v_lshl_add_u32 v158, v147, 5, v158
    v_add_u32 v158, s70, v158
    v_mul_u32_u24 v146, 1008, v146
    v_lshl_add_u32 v155, v147, 4, v146
    s_barrier
    s_waitcnt vmcnt(22) lgkmcnt(6)
    v_mfma_f32_16x16x32_bf16 v[66:69], v[106:109], v[2:5], v[66:69]
    ds_read_b64_tr_b16 v[126:127], v148 offset:5184
    v_mfma_f32_16x16x32_bf16 v[70:73], v[106:109], v[6:9], v[70:73]
    ds_read_b64_tr_b16 v[128:129], v148 offset:6336
    v_mfma_f32_16x16x32_bf16 v[74:77], v[110:113], v[2:5], v[74:77]
    ds_read_b64_tr_b16 v[130:131], v148 offset:5216
    v_mfma_f32_16x16x32_bf16 v[78:81], v[110:113], v[6:9], v[78:81]
    ds_read_b64_tr_b16 v[132:133], v148 offset:6368
    s_waitcnt lgkmcnt(4)
    v_mfma_f32_16x16x32_bf16 v[82:85], v[114:117], v[2:5], v[82:85]
    ds_read_b64_tr_b16 v[134:135], v148 offset:5248
    v_mfma_f32_16x16x32_bf16 v[86:89], v[114:117], v[6:9], v[86:89]
    ds_read_b64_tr_b16 v[136:137], v148 offset:6400
    v_mfma_f32_16x16x32_bf16 v[90:93], v[118:121], v[2:5], v[90:93]
    ds_read_b64_tr_b16 v[138:139], v148 offset:5280
    v_mfma_f32_16x16x32_bf16 v[94:97], v[118:121], v[6:9], v[94:97]
    ds_read_b64_tr_b16 v[140:141], v148 offset:6432
    v_mfma_f32_16x16x32_bf16 v[98:101], v[122:125], v[2:5], v[98:101]
    ds_read_b64_tr_b16 v[142:143], v148 offset:5312
    v_mfma_f32_16x16x32_bf16 v[102:105], v[122:125], v[6:9], v[102:105]
    ds_read_b64_tr_b16 v[144:145], v148 offset:6464
    s_waitcnt vmcnt(20) lgkmcnt(6)
    v_mfma_f32_16x16x32_bf16 v[66:69], v[126:129], v[10:13], v[66:69]
    ds_read_b64_tr_b16 v[106:107], v148 offset:10368
    v_mfma_f32_16x16x32_bf16 v[70:73], v[126:129], v[14:17], v[70:73]
    ds_read_b64_tr_b16 v[108:109], v148 offset:11520
    v_mfma_f32_16x16x32_bf16 v[74:77], v[130:133], v[10:13], v[74:77]
    ds_read_b64_tr_b16 v[110:111], v148 offset:10400
    v_mfma_f32_16x16x32_bf16 v[78:81], v[130:133], v[14:17], v[78:81]
    ds_read_b64_tr_b16 v[112:113], v148 offset:11552
    s_waitcnt lgkmcnt(4)
    v_mfma_f32_16x16x32_bf16 v[82:85], v[134:137], v[10:13], v[82:85]
    ds_read_b64_tr_b16 v[114:115], v148 offset:10432
    v_mfma_f32_16x16x32_bf16 v[86:89], v[134:137], v[14:17], v[86:89]
    ds_read_b64_tr_b16 v[116:117], v148 offset:11584
    v_mfma_f32_16x16x32_bf16 v[90:93], v[138:141], v[10:13], v[90:93]
    ds_read_b64_tr_b16 v[118:119], v148 offset:10464
    v_mfma_f32_16x16x32_bf16 v[94:97], v[138:141], v[14:17], v[94:97]
    ds_read_b64_tr_b16 v[120:121], v148 offset:11616
    v_mfma_f32_16x16x32_bf16 v[98:101], v[142:145], v[10:13], v[98:101]
    ds_read_b64_tr_b16 v[122:123], v148 offset:10496
    v_mfma_f32_16x16x32_bf16 v[102:105], v[142:145], v[14:17], v[102:105]
    ds_read_b64_tr_b16 v[124:125], v148 offset:11648
    s_waitcnt vmcnt(18) lgkmcnt(6)
    v_mfma_f32_16x16x32_bf16 v[66:69], v[106:109], v[18:21], v[66:69]
    ds_read_b64_tr_b16 v[126:127], v148 offset:15552
    v_mfma_f32_16x16x32_bf16 v[70:73], v[106:109], v[22:25], v[70:73]
    ds_read_b64_tr_b16 v[128:129], v148 offset:16704
    v_mfma_f32_16x16x32_bf16 v[74:77], v[110:113], v[18:21], v[74:77]
    ds_read_b64_tr_b16 v[130:131], v148 offset:15584
    v_mfma_f32_16x16x32_bf16 v[78:81], v[110:113], v[22:25], v[78:81]
    ds_read_b64_tr_b16 v[132:133], v148 offset:16736
    s_waitcnt lgkmcnt(4)
    v_mfma_f32_16x16x32_bf16 v[82:85], v[114:117], v[18:21], v[82:85]
    ds_read_b64_tr_b16 v[134:135], v148 offset:15616
    v_mfma_f32_16x16x32_bf16 v[86:89], v[114:117], v[22:25], v[86:89]
    ds_read_b64_tr_b16 v[136:137], v148 offset:16768
    v_mfma_f32_16x16x32_bf16 v[90:93], v[118:121], v[18:21], v[90:93]
    ds_read_b64_tr_b16 v[138:139], v148 offset:15648
    v_mfma_f32_16x16x32_bf16 v[94:97], v[118:121], v[22:25], v[94:97]
    ds_read_b64_tr_b16 v[140:141], v148 offset:16800
    v_mfma_f32_16x16x32_bf16 v[98:101], v[122:125], v[18:21], v[98:101]
    ds_read_b64_tr_b16 v[142:143], v148 offset:15680
    v_mfma_f32_16x16x32_bf16 v[102:105], v[122:125], v[22:25], v[102:105]
    ds_read_b64_tr_b16 v[144:145], v148 offset:16832
    s_waitcnt vmcnt(16) lgkmcnt(6)
    v_mfma_f32_16x16x32_bf16 v[66:69], v[126:129], v[26:29], v[66:69]
    ds_read_b64_tr_b16 v[106:107], v148 offset:20736
    v_mfma_f32_16x16x32_bf16 v[70:73], v[126:129], v[30:33], v[70:73]
    ds_read_b64_tr_b16 v[108:109], v148 offset:21888
    v_mfma_f32_16x16x32_bf16 v[74:77], v[130:133], v[26:29], v[74:77]
    ds_read_b64_tr_b16 v[110:111], v148 offset:20768
    v_mfma_f32_16x16x32_bf16 v[78:81], v[130:133], v[30:33], v[78:81]
    ds_read_b64_tr_b16 v[112:113], v148 offset:21920
    s_waitcnt lgkmcnt(4)
    v_mfma_f32_16x16x32_bf16 v[82:85], v[134:137], v[26:29], v[82:85]
    ds_read_b64_tr_b16 v[114:115], v148 offset:20800
    v_mfma_f32_16x16x32_bf16 v[86:89], v[134:137], v[30:33], v[86:89]
    ds_read_b64_tr_b16 v[116:117], v148 offset:21952
    v_mfma_f32_16x16x32_bf16 v[90:93], v[138:141], v[26:29], v[90:93]
    ds_read_b64_tr_b16 v[118:119], v148 offset:20832
    v_mfma_f32_16x16x32_bf16 v[94:97], v[138:141], v[30:33], v[94:97]
    ds_read_b64_tr_b16 v[120:121], v148 offset:21984
    v_mfma_f32_16x16x32_bf16 v[98:101], v[142:145], v[26:29], v[98:101]
    ds_read_b64_tr_b16 v[122:123], v148 offset:20864
    v_mfma_f32_16x16x32_bf16 v[102:105], v[142:145], v[30:33], v[102:105]
    ds_read_b64_tr_b16 v[124:125], v148 offset:22016
    s_waitcnt vmcnt(14) lgkmcnt(6)
    v_mfma_f32_16x16x32_bf16 v[66:69], v[106:109], v[34:37], v[66:69]
    ds_read_b64_tr_b16 v[126:127], v148 offset:25920
    v_mfma_f32_16x16x32_bf16 v[70:73], v[106:109], v[38:41], v[70:73]
    ds_read_b64_tr_b16 v[128:129], v148 offset:27072
    v_mfma_f32_16x16x32_bf16 v[74:77], v[110:113], v[34:37], v[74:77]
    ds_read_b64_tr_b16 v[130:131], v148 offset:25952
    v_mfma_f32_16x16x32_bf16 v[78:81], v[110:113], v[38:41], v[78:81]
    ds_read_b64_tr_b16 v[132:133], v148 offset:27104
    s_waitcnt lgkmcnt(4)
    v_mfma_f32_16x16x32_bf16 v[82:85], v[114:117], v[34:37], v[82:85]
    ds_read_b64_tr_b16 v[134:135], v148 offset:25984
    v_mfma_f32_16x16x32_bf16 v[86:89], v[114:117], v[38:41], v[86:89]
    ds_read_b64_tr_b16 v[136:137], v148 offset:27136
    v_mfma_f32_16x16x32_bf16 v[90:93], v[118:121], v[34:37], v[90:93]
    ds_read_b64_tr_b16 v[138:139], v148 offset:26016
    v_mfma_f32_16x16x32_bf16 v[94:97], v[118:121], v[38:41], v[94:97]
    ds_read_b64_tr_b16 v[140:141], v148 offset:27168
    v_mfma_f32_16x16x32_bf16 v[98:101], v[122:125], v[34:37], v[98:101]
    ds_read_b64_tr_b16 v[142:143], v148 offset:26048
    v_mfma_f32_16x16x32_bf16 v[102:105], v[122:125], v[38:41], v[102:105]
    ds_read_b64_tr_b16 v[144:145], v148 offset:27200
    s_waitcnt vmcnt(12) lgkmcnt(6)
    v_mfma_f32_16x16x32_bf16 v[66:69], v[126:129], v[42:45], v[66:69]
    ds_read_b64_tr_b16 v[106:107], v148 offset:31104
    v_mfma_f32_16x16x32_bf16 v[70:73], v[126:129], v[46:49], v[70:73]
    ds_read_b64_tr_b16 v[108:109], v148 offset:32256
    v_mfma_f32_16x16x32_bf16 v[74:77], v[130:133], v[42:45], v[74:77]
    ds_read_b64_tr_b16 v[110:111], v148 offset:31136
    v_mfma_f32_16x16x32_bf16 v[78:81], v[130:133], v[46:49], v[78:81]
    ds_read_b64_tr_b16 v[112:113], v148 offset:32288
    s_waitcnt lgkmcnt(4)
    v_mfma_f32_16x16x32_bf16 v[82:85], v[134:137], v[42:45], v[82:85]
    ds_read_b64_tr_b16 v[114:115], v148 offset:31168
    v_mfma_f32_16x16x32_bf16 v[86:89], v[134:137], v[46:49], v[86:89]
    ds_read_b64_tr_b16 v[116:117], v148 offset:32320
    v_mfma_f32_16x16x32_bf16 v[90:93], v[138:141], v[42:45], v[90:93]
    ds_read_b64_tr_b16 v[118:119], v148 offset:31200
    v_mfma_f32_16x16x32_bf16 v[94:97], v[138:141], v[46:49], v[94:97]
    ds_read_b64_tr_b16 v[120:121], v148 offset:32352
    v_mfma_f32_16x16x32_bf16 v[98:101], v[142:145], v[42:45], v[98:101]
    ds_read_b64_tr_b16 v[122:123], v148 offset:31232
    v_mfma_f32_16x16x32_bf16 v[102:105], v[142:145], v[46:49], v[102:105]
    ds_read_b64_tr_b16 v[124:125], v148 offset:32384
    s_waitcnt vmcnt(10) lgkmcnt(6)
    v_mfma_f32_16x16x32_bf16 v[66:69], v[106:109], v[50:53], v[66:69]
    ds_read_b64_tr_b16 v[126:127], v148 offset:36288
    v_mfma_f32_16x16x32_bf16 v[70:73], v[106:109], v[54:57], v[70:73]
    ds_read_b64_tr_b16 v[128:129], v148 offset:37440
    v_mfma_f32_16x16x32_bf16 v[74:77], v[110:113], v[50:53], v[74:77]
    ds_read_b64_tr_b16 v[130:131], v148 offset:36320
    v_mfma_f32_16x16x32_bf16 v[78:81], v[110:113], v[54:57], v[78:81]
    ds_read_b64_tr_b16 v[132:133], v148 offset:37472
    s_waitcnt lgkmcnt(4)
    v_mfma_f32_16x16x32_bf16 v[82:85], v[114:117], v[50:53], v[82:85]
    ds_read_b64_tr_b16 v[134:135], v148 offset:36352
    v_mfma_f32_16x16x32_bf16 v[86:89], v[114:117], v[54:57], v[86:89]
    ds_read_b64_tr_b16 v[136:137], v148 offset:37504
    v_mfma_f32_16x16x32_bf16 v[90:93], v[118:121], v[50:53], v[90:93]
    ds_read_b64_tr_b16 v[138:139], v148 offset:36384
    v_mfma_f32_16x16x32_bf16 v[94:97], v[118:121], v[54:57], v[94:97]
    ds_read_b64_tr_b16 v[140:141], v148 offset:37536
    v_mfma_f32_16x16x32_bf16 v[98:101], v[122:125], v[50:53], v[98:101]
    ds_read_b64_tr_b16 v[142:143], v148 offset:36416
    v_mfma_f32_16x16x32_bf16 v[102:105], v[122:125], v[54:57], v[102:105]
    ds_read_b64_tr_b16 v[144:145], v148 offset:37568
    s_waitcnt vmcnt(8) lgkmcnt(6)
    v_mfma_f32_16x16x32_bf16 v[66:69], v[126:129], v[58:61], v[66:69]
    ds_read_b64_tr_b16 v[106:107], v149 offset:0
    v_mfma_f32_16x16x32_bf16 v[70:73], v[126:129], v[62:65], v[70:73]
    ds_read_b64_tr_b16 v[108:109], v149 offset:5184
    v_mfma_f32_16x16x32_bf16 v[74:77], v[130:133], v[58:61], v[74:77]
    ds_read_b64_tr_b16 v[110:111], v149 offset:32
    v_mfma_f32_16x16x32_bf16 v[78:81], v[130:133], v[62:65], v[78:81]
    ds_read_b64_tr_b16 v[112:113], v149 offset:5216
    s_waitcnt lgkmcnt(4)
    v_mfma_f32_16x16x32_bf16 v[82:85], v[134:137], v[58:61], v[82:85]
    ds_read_b64_tr_b16 v[114:115], v149 offset:64
    v_mfma_f32_16x16x32_bf16 v[86:89], v[134:137], v[62:65], v[86:89]
    ds_read_b64_tr_b16 v[116:117], v149 offset:5248
    v_mfma_f32_16x16x32_bf16 v[90:93], v[138:141], v[58:61], v[90:93]
    ds_read_b64_tr_b16 v[118:119], v149 offset:96
    v_mfma_f32_16x16x32_bf16 v[94:97], v[138:141], v[62:65], v[94:97]
    ds_read_b64_tr_b16 v[120:121], v149 offset:5280
    v_mfma_f32_16x16x32_bf16 v[98:101], v[142:145], v[58:61], v[98:101]
    ds_read_b64_tr_b16 v[122:123], v149 offset:128
    v_mfma_f32_16x16x32_bf16 v[102:105], v[142:145], v[62:65], v[102:105]
    ds_read_b64_tr_b16 v[124:125], v149 offset:5312
    s_waitcnt vmcnt(0) lgkmcnt(6)
    v_mfma_f32_16x16x32_bf16 v[66:69], v[106:109], v[160:163], v[66:69]
    v_mfma_f32_16x16x32_bf16 v[70:73], v[106:109], v[164:167], v[70:73]
    v_mfma_f32_16x16x32_bf16 v[74:77], v[110:113], v[160:163], v[74:77]
    v_mfma_f32_16x16x32_bf16 v[78:81], v[110:113], v[164:167], v[78:81]
    s_waitcnt lgkmcnt(0)
    v_mfma_f32_16x16x32_bf16 v[82:85], v[114:117], v[160:163], v[82:85]
    v_mfma_f32_16x16x32_bf16 v[86:89], v[114:117], v[164:167], v[86:89]
    v_mfma_f32_16x16x32_bf16 v[90:93], v[118:121], v[160:163], v[90:93]
    v_mfma_f32_16x16x32_bf16 v[94:97], v[118:121], v[164:167], v[94:97]
    v_mfma_f32_16x16x32_bf16 v[98:101], v[122:125], v[160:163], v[98:101]
    v_mfma_f32_16x16x32_bf16 v[102:105], v[122:125], v[164:167], v[102:105]
    ds_write_b128 v152, v[66:69] offset:0
    ds_write_b128 v152, v[70:73] offset:4864
    ds_write_b128 v152, v[74:77] offset:64
    ds_write_b128 v152, v[78:81] offset:4928
    ds_write_b128 v152, v[82:85] offset:128
    ds_write_b128 v152, v[86:89] offset:4992
    ds_write_b128 v152, v[90:93] offset:192
    ds_write_b128 v152, v[94:97] offset:5056
    s_mov_b64 exec, 0xffffffff
    ds_write_b128 v152, v[98:101] offset:256
    ds_write_b128 v152, v[102:105] offset:5120
    s_mov_b64 exec, -1
    s_waitcnt lgkmcnt(0)
    s_barrier
    ds_read_b128 v[4:7], v156 offset:0
    ds_read_b128 v[8:11], v156 offset:16
    ds_read_b128 v[12:15], v156 offset:19456
    ds_read_b128 v[16:19], v156 offset:19472
    ds_read_b128 v[20:23], v157 offset:0
    ds_read_b128 v[24:27], v157 offset:16
    ds_read_b128 v[28:31], v157 offset:19456
    ds_read_b128 v[32:35], v157 offset:19472
    ds_read_b128 v[36:39], v158 offset:0
    ds_read_b128 v[40:43], v158 offset:16
    ds_read_b128 v[44:47], v158 offset:19456
    ds_read_b128 v[48:51], v158 offset:19472
    s_waitcnt lgkmcnt(8)
    v_add_f32 v4, v4, v12
    v_add_f32 v5, v5, v13
    v_add_f32 v6, v6, v14
    v_add_f32 v7, v7, v15
    v_add_f32 v8, v8, v16
    v_add_f32 v9, v9, v17
    v_add_f32 v10, v10, v18
    v_add_f32 v11, v11, v19
    v_cvt_pk_bf16_f32 v56, v4, v5
    v_cvt_pk_bf16_f32 v57, v6, v7
    v_cvt_pk_bf16_f32 v58, v8, v9
    v_cvt_pk_bf16_f32 v59, v10, v11
    buffer_store_dwordx4 v[56:59], v153, s[12:15], s48 offen nt
    s_waitcnt lgkmcnt(4)
    v_add_f32 v20, v20, v28
    v_add_f32 v21, v21, v29
    v_add_f32 v22, v22, v30
    v_add_f32 v23, v23, v31
    v_add_f32 v24, v24, v32
    v_add_f32 v25, v25, v33
    v_add_f32 v26, v26, v34
    v_add_f32 v27, v27, v35
    v_cvt_pk_bf16_f32 v60, v20, v21
    v_cvt_pk_bf16_f32 v61, v22, v23
    v_cvt_pk_bf16_f32 v62, v24, v25
    v_cvt_pk_bf16_f32 v63, v26, v27
    buffer_store_dwordx4 v[60:63], v154, s[12:15], s48 offen nt
    s_waitcnt lgkmcnt(0)
    v_add_f32 v36, v36, v44
    v_add_f32 v37, v37, v45
    v_add_f32 v38, v38, v46
    v_add_f32 v39, v39, v47
    v_add_f32 v40, v40, v48
    v_add_f32 v41, v41, v49
    v_add_f32 v42, v42, v50
    v_add_f32 v43, v43, v51
    v_cvt_pk_bf16_f32 v64, v36, v37
    v_cvt_pk_bf16_f32 v65, v38, v39
    v_cvt_pk_bf16_f32 v66, v40, v41
    v_cvt_pk_bf16_f32 v67, v42, v43
    s_mov_b64 exec, 0xffff
    buffer_store_dwordx4 v[64:67], v155, s[12:15], s48 offen nt
    s_endpgm
A_W2:
    s_mov_b32 s65, 160000
LL_W2:
    ds_read_b32 v129, v131 offset:48
    s_waitcnt lgkmcnt(0)
    v_cmp_gt_u32 s[66:67], 1, v129
    s_nop 0
    s_cmp_eq_u64 s[66:67], 0
    s_cbranch_scc1 LD_W2
    s_sleep 1
    s_sub_u32 s65, s65, 1
    s_cmp_lg_u32 s65, 0
    s_cbranch_scc1 LL_W2
LD_W2:
    s_branch A_R2
A_W6:
    s_mov_b32 s65, 160000
LL_W6:
    ds_read_b32 v129, v128 offset:8
    s_waitcnt lgkmcnt(0)
    v_readfirstlane_b32 s66, v129
    s_nop 0
    s_cmp_ge_u32 s66, 3
    s_cbranch_scc1 LD_W6
    s_sleep 1
    s_sub_u32 s65, s65, 1
    s_cmp_lg_u32 s65, 0
    s_cbranch_scc1 LL_W6
LD_W6:
    s_branch A_R6
A_W10:
    s_mov_b32 s65, 160000
LL_W10:
    ds_read_b32 v129, v128 offset:8
    s_waitcnt lgkmcnt(0)
    v_readfirstlane_b32 s66, v129
    s_nop 0
    s_cmp_ge_u32 s66, 5
    s_cbranch_scc1 LD_W10
    s_sleep 1
    s_sub_u32 s65, s65, 1
    s_cmp_lg_u32 s65, 0
    s_cbranch_scc1 LL_W10
LD_W10:
    s_branch A_R10
A_W18:
    s_mov_b32 s65, 160000
LL_W18:
    ds_read_b32 v129, v128 offset:8
    s_waitcnt lgkmcnt(0)
    v_readfirstlane_b32 s66, v129
    s_nop 0
    s_cmp_ge_u32 s66, 8
    s_cbranch_scc1 LD_W18
    s_sleep 1
    s_sub_u32 s65, s65, 1
    s_cmp_lg_u32 s65, 0
    s_cbranch_scc1 LL_W18
LD_W18:
    s_branch A_R18
A_SLOW:
    s_mul_i32 s36, s61, 139264
    s_add_u32 s36, s36, 2097152
    s_lshr_b32 s37, s61, 1
    s_lshl_b32 s37, s37, 16
    s_and_b32 s38, s61, 1
    s_lshl_b32 s38, s38, 2
    s_add_u32 s37, s37, s38
    s_add_u32 s37, s37, 14716928
    v_and_b32 v125, 31, v1
    v_lshrrev_b32 v126, 5, v1
    v_lshlrev_b32 v117, 3, v1
    v_lshlrev_b32 v119, 3, v125
    v_lshl_add_u32 v119, v126, 10, v119
    v_cmp_gt_u32 s[34:35], 18, v125
    v_min_u32 v125, 17, v125
    v_lshrrev_b32 v118, 4, v125
    v_xor_b32 v118, v118, v126
    v_lshlrev_b32 v118, 4, v118
    v_lshl_add_u32 v118, v125, 5, v118
    v_mov_b32 v89, 0
    v_mov_b32 v122, 0xff800000
    s_mov_b32 s44, 0
A_SP:
    s_mov_b32 s39, 0
A_SL:
    s_lshr_b32 s40, s39, 2
    s_mul_i32 s40, s40, 17408
    s_add_u32 s40, s40, s36
    s_and_b32 s41, s39, 3
    s_mul_i32 s42, s41, 2304
    s_add_u32 s42, s42, s40
    s_add_u32 s42, s42, 8192
    s_lshl_b32 s41, s41, 11
    s_add_u32 s40, s40, s41
    s_lshl_b32 s41, s39, 11
    s_add_u32 s41, s41, s37
    buffer_load_dword v90, v119, s[16:19], s41 offen sc1
    buffer_load_dwordx2 v[92:93], v117, s[16:19], s40 offen sc1
    buffer_load_dwordx2 v[94:95], v117, s[16:19], s40 offen offset:512 sc1
    buffer_load_dwordx2 v[96:97], v117, s[16:19], s40 offen offset:1024 sc1
    buffer_load_dwordx2 v[98:99], v117, s[16:19], s40 offen offset:1536 sc1
    buffer_load_dwordx4 v[100:103], v118, s[16:19], s42 offen offset:0 sc1
    buffer_load_dwordx4 v[104:107], v118, s[16:19], s42 offen offset:576 sc1
    buffer_load_dwordx4 v[108:111], v118, s[16:19], s42 offen offset:1152 sc1
    buffer_load_dwordx4 v[112:115], v118, s[16:19], s42 offen offset:1728 sc1
    s_waitcnt vmcnt(0)
    v_mfma_f32_32x32x4_2b_bf16 v[20:51], v[90:91], v[88:89], 0
    s_nop 15
    s_nop 1
    v_mfma_f32_32x32x16_bf16 v[20:35], v[92:95], v[84:87], v[20:35]
    v_mfma_f32_32x32x16_bf16 v[36:51], v[96:99], v[84:87], v[36:51]
    s_nop 11
    s_cmp_lg_u32 s44, 0
    s_cbranch_scc1 A_S2
    v_max3_f32 v122, v122, v20, v21
    v_max3_f32 v122, v122, v22, v23
    v_max3_f32 v122, v122, v24, v25
    v_max3_f32 v122, v122, v26, v27
    v_max3_f32 v122, v122, v28, v29
    v_max3_f32 v122, v122, v30, v31
    v_max3_f32 v122, v122, v32, v33
    v_max3_f32 v122, v122, v34, v35
    v_max3_f32 v122, v122, v36, v37
    v_max3_f32 v122, v122, v38, v39
    v_max3_f32 v122, v122, v40, v41
    v_max3_f32 v122, v122, v42, v43
    v_max3_f32 v122, v122, v44, v45
    v_max3_f32 v122, v122, v46, v47
    v_max3_f32 v122, v122, v48, v49
    v_max3_f32 v122, v122, v50, v51
    s_branch A_SN
A_S2:
    v_cndmask_b32 v100, v91, v100, s[34:35]
    v_cndmask_b32 v101, v91, v101, s[34:35]
    v_cndmask_b32 v102, v91, v102, s[34:35]
    v_cndmask_b32 v103, v91, v103, s[34:35]
    v_cndmask_b32 v104, v91, v104, s[34:35]
    v_cndmask_b32 v105, v91, v105, s[34:35]
    v_cndmask_b32 v106, v91, v106, s[34:35]
    v_cndmask_b32 v107, v91, v107, s[34:35]
    v_cndmask_b32 v108, v91, v108, s[34:35]
    v_cndmask_b32 v109, v91, v109, s[34:35]
    v_cndmask_b32 v110, v91, v110, s[34:35]
    v_cndmask_b32 v111, v91, v111, s[34:35]
    v_cndmask_b32 v112, v91, v112, s[34:35]
    v_cndmask_b32 v113, v91, v113, s[34:35]
    v_cndmask_b32 v114, v91, v114, s[34:35]
    v_cndmask_b32 v115, v91, v115, s[34:35]
    v_exp_f32 v20, v20
    v_exp_f32 v21, v21
    v_exp_f32 v22, v22
    v_exp_f32 v23, v23
    v_exp_f32 v24, v24
    v_exp_f32 v25, v25
    v_exp_f32 v26, v26
    v_exp_f32 v27, v27
    v_exp_f32 v28, v28
    v_exp_f32 v29, v29
    v_exp_f32 v30, v30
    v_exp_f32 v31, v31
    v_exp_f32 v32, v32
    v_exp_f32 v33, v33
    v_exp_f32 v34, v34
    v_exp_f32 v35, v35
    v_exp_f32 v36, v36
    v_exp_f32 v37, v37
    v_exp_f32 v38, v38
    v_exp_f32 v39, v39
    v_exp_f32 v40, v40
    v_exp_f32 v41, v41
    v_exp_f32 v42, v42
    v_exp_f32 v43, v43
    v_exp_f32 v44, v44
    v_exp_f32 v45, v45
    v_exp_f32 v46, v46
    v_exp_f32 v47, v47
    v_exp_f32 v48, v48
    v_exp_f32 v49, v49
    v_exp_f32 v50, v50
    v_exp_f32 v51, v51
    s_nop 1
    v_smfmac_f32_32x32x32_bf16 v[2:17], v[100:103], v[20:27], v116
    v_smfmac_f32_32x32x32_bf16 v[2:17], v[104:107], v[28:35], v116
    v_smfmac_f32_32x32x32_bf16 v[2:17], v[108:111], v[36:43], v116
    v_smfmac_f32_32x32x32_bf16 v[2:17], v[112:115], v[44:51], v116
    s_nop 11
A_SN:
    s_add_u32 s39, s39, 1
    s_cmp_lt_u32 s39, 32
    s_cbranch_scc1 A_SL
    s_cmp_lg_u32 s44, 0
    s_cbranch_scc1 A_SF
    s_mov_b32 s44, 1
    v_mov_b32 v123, v122
    s_nop 1
    v_permlane32_swap_b32 v122, v123
    v_max_f32 v122, v122, v123
    v_cvt_pk_bf16_f32 v123, -v122, -v122
    v_and_b32 v123, 0xffff0000, v123
    v_sub_f32 v124, -v122, v123
    v_cvt_pk_bf16_f32 v89, v123, v124
    v_mov_b32 v2, 0
    v_mov_b32 v3, 0
    v_mov_b32 v4, 0
    v_mov_b32 v5, 0
    v_mov_b32 v6, 0
    v_mov_b32 v7, 0
    v_mov_b32 v8, 0
    v_mov_b32 v9, 0
    v_mov_b32 v10, 0
    v_mov_b32 v11, 0
    v_mov_b32 v12, 0
    v_mov_b32 v13, 0
    v_mov_b32 v14, 0
    v_mov_b32 v15, 0
    v_mov_b32 v16, 0
    v_mov_b32 v17, 0
    s_branch A_SP
A_SF:
    v_rcp_f32 v122, v12
    v_lshlrev_b32 v117, 4, v1
    v_lshlrev_b32 v119, 2, v1
    v_mov_b32 v92, 0
    v_mov_b32 v93, s60
    s_branch A_FIN
F_END:
    s_endpgm
.section .rodata,"a"
.p2align 6
.amdhsa_kernel gated_mix__ssm_conv_s4__mha_block__prompt_kernel
  .amdhsa_next_free_vgpr 168
  .amdhsa_next_free_sgpr 102
  .amdhsa_accum_offset 168
  .amdhsa_group_segment_fixed_size 0
  .amdhsa_kernarg_size 128
  .amdhsa_user_sgpr_count 2
  .amdhsa_user_sgpr_kernarg_segment_ptr 1
  .amdhsa_system_sgpr_workgroup_id_x 1
.end_amdhsa_kernel
```
